```python
import torch

def _softmax(x, axis=-1):
    return torch.softmax(x, dim=axis)
def _gelu(x):
    return torch.nn.functional.gelu(x, approximate="tanh")
def _silu(x):
    return torch.nn.functional.silu(x)
def _sigmoid(x):
    return torch.sigmoid(x)
def _layernorm(x, axis=-1, eps=1e-5):
    m = x.mean(dim=axis, keepdim=True)
    v = x.var(dim=axis, keepdim=True, unbiased=False)
    return (x - m) / torch.sqrt(v + eps)
def _scatter_add(tgt, idx, src, axis=0):
    return tgt.clone().index_add_(axis, idx, src)
def _segment_sum(src, seg, n):
    out = torch.zeros((n,) + src.shape[1:], dtype=src.dtype)
    return out.index_add_(0, seg, src)
def _pad(x, pw):
    flat = tuple(v for pair in reversed(pw) for v in pair)
    return torch.nn.functional.pad(x, flat)

kernel_name = 'standalone__gqa_softmax__near_ridge'

def setup_inputs():

    _w = (lambda a: (lambda t: t.to(torch.bfloat16) if t.is_floating_point() else t)(torch.as_tensor(a)))
    B, Hq, Hkv, Sq, Sk, D = 8, 32, 32, 192, 1024, 128
    return {
        "q": _w((lambda *s: torch.randn(*s, dtype=torch.bfloat16) * 0.8)(B, Hq, Sq, D)),
        "k": _w((lambda *s: torch.randn(*s, dtype=torch.bfloat16) * 0.8)(B, Hkv, Sk, D)),
        "v": _w((lambda *s: torch.randn(*s, dtype=torch.bfloat16) * 0.05)(B, Hkv, Sk, D)),
    }

def reference(q, k, v):
    B, Hq, Sq, D = q.shape
    Hkv = k.shape[1]
    rep = Hq // Hkv
    k = (lambda x, n, axis: torch.repeat_interleave(x, n, dim=axis))(k, rep, axis=1)
    v = (lambda x, n, axis: torch.repeat_interleave(x, n, dim=axis))(v, rep, axis=1)
    scale = D ** -0.5
    scores = torch.einsum("bhqd,bhkd->bhqk", q, k) * scale
    p = _softmax(scores, axis=-1)
    return torch.einsum("bhqk,bhkd->bhqd", p, v)
```

```asm
; @launch grid=(256,1,1) block=(512,1,1) lds=163840
.amdgcn_target "amdgcn-amd-amdhsa--gfx950"
.text
.globl standalone__gqa_softmax__near_ridge_kernel
.p2align 8
.type standalone__gqa_softmax__near_ridge_kernel,@function
standalone__gqa_softmax__near_ridge_kernel:
    s_cmp_ge_u32 s2, 256
    s_cbranch_scc1 L_end
    s_load_dwordx8 s[4:11], s[0:1], 0
    v_lshrrev_b32 v1, 6, v0
    v_and_b32 v0, 63, v0
    s_and_b32 s3, s2, 7
    s_lshl_b32 s3, s3, 5
    s_lshr_b32 s2, s2, 3
    s_or_b32 s2, s2, s3
    v_readfirstlane_b32 s28, v1
    v_and_b32 v2, 15, v0
    v_lshrrev_b32 v3, 4, v0
    s_mul_i32 s37, s2, 49152
    s_lshl_b32 s38, s2, 18
    s_cmp_lt_u32 s28, 4
    s_cbranch_scc1 L_compute
    s_sub_u32 s28, s28, 4
    s_lshl_b32 s31, s28, 9
    v_lshlrev_b32 v10, 11, v3
    v_lshl_add_u32 v10, v2, 4, v10
    v_add_u32 v10, s31, v10
    v_add_u32 v11, 256, v10
    s_mul_i32 s36, s28, 2112
    s_mov_b32 s18, 262144
    s_mov_b32 s19, 0x00020000
    s_setprio 3
    s_waitcnt lgkmcnt(0)
    s_add_u32 s16, s6, s38
    s_addc_u32 s17, s7, 0
    s_and_b32 s17, s17, 0xffff
    s_mov_b32 s34, 0
    s_add_u32 m0, s36, 118272
    s_nop 0
    buffer_load_dwordx4 v10, s[16:19], s34 offen nt lds
    s_add_u32 m0, s36, 119328
    s_nop 0
    buffer_load_dwordx4 v11, s[16:19], s34 offen nt lds
    s_add_u32 s12, s4, s37
    s_addc_u32 s13, s5, 0
    s_and_b32 s13, s13, 0xffff
    s_mov_b32 s14, 49152
    s_mov_b32 s15, 0x00020000
    s_mov_b32 s34, 0
    s_add_u32 m0, s36, 67584
    s_nop 0
    buffer_load_dwordx4 v10, s[12:15], s34 offen nt lds
    s_add_u32 m0, s36, 68640
    s_nop 0
    buffer_load_dwordx4 v11, s[12:15], s34 offen nt lds
    s_mov_b32 s34, 8192
    s_add_u32 m0, s36, 76032
    s_nop 0
    buffer_load_dwordx4 v10, s[12:15], s34 offen nt lds
    s_add_u32 m0, s36, 77088
    s_nop 0
    buffer_load_dwordx4 v11, s[12:15], s34 offen nt lds
    s_mov_b32 s34, 16384
    s_add_u32 m0, s36, 84480
    s_nop 0
    buffer_load_dwordx4 v10, s[12:15], s34 offen nt lds
    s_add_u32 m0, s36, 85536
    s_nop 0
    buffer_load_dwordx4 v11, s[12:15], s34 offen nt lds
    s_mov_b32 s3, 16896
    v_mul_u32_u24 v4, s3, v0
    v_add_u32 v4, 1024, v4
    v_and_b32 v5, 3, v0
    v_mul_u32_u24 v5, 1056, v5
    v_add_u32 v5, 2080, v5
    v_cmp_gt_u32 vcc, 8, v0
    v_mov_b32 v20, 1
    v_mov_b32 v12, 0
    v_cndmask_b32 v4, v5, v4, vcc
    ds_write_b32 v4, v12
    v_mov_b32 v13, 67584
    v_mov_b32 v254, 135168
    s_add_u32 s20, s8, s38
    s_addc_u32 s21, s9, 0
    s_and_b32 s21, s21, 0xffff
    s_mov_b32 s22, 262144
    s_mov_b32 s23, 0x00020000
    s_waitcnt lgkmcnt(0)
    s_barrier
    s_waitcnt vmcnt(7)
    s_mov_b32 s34, 24576
    s_add_u32 m0, s36, 92928
    s_nop 0
    buffer_load_dwordx4 v10, s[12:15], s34 offen nt lds
    s_waitcnt vmcnt(7)
    s_add_u32 m0, s36, 93984
    s_nop 0
    buffer_load_dwordx4 v11, s[12:15], s34 offen nt lds
    s_waitcnt vmcnt(7)
    s_mov_b32 s34, 32768
    s_add_u32 m0, s36, 101376
    s_nop 0
    buffer_load_dwordx4 v10, s[12:15], s34 offen nt lds
    s_waitcnt vmcnt(7)
    s_add_u32 m0, s36, 102432
    s_nop 0
    buffer_load_dwordx4 v11, s[12:15], s34 offen nt lds
    s_waitcnt vmcnt(7)
    s_mov_b32 s34, 40960
    s_add_u32 m0, s36, 109824
    s_nop 0
    buffer_load_dwordx4 v10, s[12:15], s34 offen nt lds
    s_waitcnt vmcnt(7)
    s_mov_b64 exec, 1
    ds_add_u32 v12, v20 offset:2080
    s_mov_b64 exec, -1
    s_add_u32 m0, s36, 110880
    s_nop 0
    buffer_load_dwordx4 v11, s[12:15], s34 offen nt lds
    s_waitcnt vmcnt(1)
    s_mov_b64 exec, 1
    ds_add_u32 v12, v20 offset:3136
    s_mov_b64 exec, -1
    s_mov_b64 exec, 1
    ds_add_u32 v12, v20 offset:4192
    s_mov_b64 exec, -1
    s_mov_b32 s34, 8192
    s_add_u32 m0, s36, 0
    s_nop 0
    buffer_load_dwordx4 v10, s[16:19], s34 offen nt lds
    s_add_u32 m0, s36, 1056
    s_nop 0
    buffer_load_dwordx4 v11, s[16:19], s34 offen nt lds
    s_waitcnt vmcnt(1)
    s_mov_b64 exec, 1
    ds_add_u32 v12, v20 offset:5248
    s_mov_b64 exec, -1
    s_mov_b32 s34, 0
    s_add_u32 m0, s36, 8448
    s_nop 0
    buffer_load_dwordx4 v10, s[20:23], s34 offen nt lds
    s_add_u32 m0, s36, 9504
    s_nop 0
    buffer_load_dwordx4 v11, s[20:23], s34 offen nt lds
    s_waitcnt vmcnt(1)
    s_mov_b32 s34, 16384
    s_add_u32 m0, s36, 16896
    s_nop 0
    buffer_load_dwordx4 v10, s[16:19], s34 offen nt lds
    s_add_u32 m0, s36, 17952
    s_nop 0
    buffer_load_dwordx4 v11, s[16:19], s34 offen nt lds
    s_waitcnt vmcnt(1)
    s_mov_b64 exec, 1
    ds_add_u32 v12, v20 offset:1024
    s_mov_b64 exec, -1
    s_mov_b32 s34, 8192
    s_add_u32 m0, s36, 25344
    s_nop 0
    buffer_load_dwordx4 v10, s[20:23], s34 offen nt lds
    s_add_u32 m0, s36, 26400
    s_nop 0
    buffer_load_dwordx4 v11, s[20:23], s34 offen nt lds
    s_waitcnt vmcnt(2)
    s_mov_b32 s34, 24576
    s_add_u32 m0, s36, 33792
    s_nop 0
    buffer_load_dwordx4 v10, s[16:19], s34 offen nt lds
    s_waitcnt vmcnt(2)
    s_add_u32 m0, s36, 34848
    s_nop 0
    buffer_load_dwordx4 v11, s[16:19], s34 offen nt lds
    s_waitcnt vmcnt(2)
    s_mov_b64 exec, 1
    ds_add_u32 v12, v20 offset:17920
    s_mov_b64 exec, -1
    s_mov_b32 s34, 16384
    s_add_u32 m0, s36, 42240
    s_nop 0
    buffer_load_dwordx4 v10, s[20:23], s34 offen nt lds
    s_waitcnt vmcnt(2)
    s_add_u32 m0, s36, 43296
    s_nop 0
    buffer_load_dwordx4 v11, s[20:23], s34 offen nt lds
    s_waitcnt vmcnt(2)
    s_mov_b32 s34, 32768
    s_add_u32 m0, s36, 50688
    s_nop 0
    buffer_load_dwordx4 v10, s[16:19], s34 offen nt lds
    s_waitcnt vmcnt(2)
    s_add_u32 m0, s36, 51744
    s_nop 0
    buffer_load_dwordx4 v11, s[16:19], s34 offen nt lds
    s_waitcnt vmcnt(2)
    s_mov_b64 exec, 1
    ds_add_u32 v12, v20 offset:34816
    s_mov_b64 exec, -1
    s_mov_b32 s34, 24576
    s_add_u32 m0, s36, 59136
    s_nop 0
    buffer_load_dwordx4 v10, s[20:23], s34 offen nt lds
    s_waitcnt vmcnt(2)
    s_add_u32 m0, s36, 60192
    s_nop 0
    buffer_load_dwordx4 v11, s[20:23], s34 offen nt lds
    s_waitcnt vmcnt(2)
L_lp5:
    ds_read_b128 v[16:19], v254
    s_waitcnt lgkmcnt(0)
    v_min3_u32 v16, v16, v17, v18
    v_min_u32 v16, v16, v19
    v_cmp_gt_u32 vcc, 1, v16
    s_cbranch_vccnz L_lp5_slp
    s_mov_b32 s34, 40960
    s_add_u32 m0, s36, 67584
    s_nop 0
    buffer_load_dwordx4 v10, s[16:19], s34 offen nt lds
    s_waitcnt vmcnt(2)
    s_add_u32 m0, s36, 68640
    s_nop 0
    buffer_load_dwordx4 v11, s[16:19], s34 offen nt lds
    s_waitcnt vmcnt(2)
    s_mov_b64 exec, 1
    ds_add_u32 v12, v20 offset:51712
    s_mov_b64 exec, -1
    s_mov_b32 s34, 32768
    s_add_u32 m0, s36, 76032
    s_nop 0
    buffer_load_dwordx4 v10, s[20:23], s34 offen nt lds
    s_waitcnt vmcnt(2)
    s_add_u32 m0, s36, 77088
    s_nop 0
    buffer_load_dwordx4 v11, s[20:23], s34 offen nt lds
    s_waitcnt vmcnt(2)
    s_mov_b32 s34, 49152
    s_add_u32 m0, s36, 84480
    s_nop 0
    buffer_load_dwordx4 v10, s[16:19], s34 offen nt lds
    s_waitcnt vmcnt(2)
    s_add_u32 m0, s36, 85536
    s_nop 0
    buffer_load_dwordx4 v11, s[16:19], s34 offen nt lds
    s_waitcnt vmcnt(2)
    s_mov_b64 exec, 1
    ds_add_u32 v13, v20 offset:1024
    s_mov_b64 exec, -1
    s_mov_b32 s34, 40960
    s_add_u32 m0, s36, 92928
    s_nop 0
    buffer_load_dwordx4 v10, s[20:23], s34 offen nt lds
    s_waitcnt vmcnt(2)
    s_add_u32 m0, s36, 93984
    s_nop 0
    buffer_load_dwordx4 v11, s[20:23], s34 offen nt lds
    s_mov_b32 s34, 57344
    s_add_u32 m0, s36, 101376
    s_nop 0
    buffer_load_dwordx4 v10, s[16:19], s34 offen nt lds
    s_waitcnt vmcnt(3)
    s_add_u32 m0, s36, 102432
    s_nop 0
    buffer_load_dwordx4 v11, s[16:19], s34 offen nt lds
    s_waitcnt vmcnt(3)
    s_mov_b32 s34, 49152
    s_add_u32 m0, s36, 109824
    s_nop 0
    buffer_load_dwordx4 v10, s[20:23], s34 offen nt lds
    s_waitcnt vmcnt(3)
    s_mov_b64 exec, 1
    ds_add_u32 v13, v20 offset:17920
    s_mov_b64 exec, -1
    s_add_u32 m0, s36, 110880
    s_nop 0
    buffer_load_dwordx4 v11, s[20:23], s34 offen nt lds
    s_waitcnt vmcnt(3)
L_lp8:
    ds_read_b128 v[16:19], v254
    s_waitcnt lgkmcnt(0)
    v_min3_u32 v16, v16, v17, v18
    v_min_u32 v16, v16, v19
    v_cmp_gt_u32 vcc, 4, v16
    s_cbranch_vccnz L_lp8_slp
    s_mov_b32 s34, 65536
    s_add_u32 m0, s36, 118272
    s_nop 0
    buffer_load_dwordx4 v10, s[16:19], s34 offen nt lds
    s_waitcnt vmcnt(3)
    s_add_u32 m0, s36, 119328
    s_nop 0
    buffer_load_dwordx4 v11, s[16:19], s34 offen nt lds
    s_waitcnt vmcnt(3)
    s_mov_b32 s34, 57344
    s_add_u32 m0, s36, 126720
    s_nop 0
    buffer_load_dwordx4 v10, s[20:23], s34 offen nt lds
    s_waitcnt vmcnt(3)
    s_mov_b64 exec, 1
    ds_add_u32 v13, v20 offset:34816
    s_mov_b64 exec, -1
    s_add_u32 m0, s36, 127776
    s_nop 0
    buffer_load_dwordx4 v11, s[20:23], s34 offen nt lds
    s_waitcnt vmcnt(3)
    s_mov_b32 s34, 73728
    s_add_u32 m0, s36, 0
    s_nop 0
    buffer_load_dwordx4 v10, s[16:19], s34 offen nt lds
    s_waitcnt vmcnt(3)
    s_add_u32 m0, s36, 1056
    s_nop 0
    buffer_load_dwordx4 v11, s[16:19], s34 offen nt lds
    s_waitcnt vmcnt(3)
    s_mov_b32 s34, 65536
    s_add_u32 m0, s36, 8448
    s_nop 0
    buffer_load_dwordx4 v10, s[20:23], s34 offen nt lds
    s_waitcnt vmcnt(3)
    s_mov_b64 exec, 1
    ds_add_u32 v13, v20 offset:51712
    s_mov_b64 exec, -1
    s_add_u32 m0, s36, 9504
    s_nop 0
    buffer_load_dwordx4 v11, s[20:23], s34 offen nt lds
    s_waitcnt vmcnt(3)
    s_mov_b32 s34, 81920
    s_add_u32 m0, s36, 16896
    s_nop 0
    buffer_load_dwordx4 v10, s[16:19], s34 offen nt lds
    s_waitcnt vmcnt(3)
    s_add_u32 m0, s36, 17952
    s_nop 0
    buffer_load_dwordx4 v11, s[16:19], s34 offen nt lds
    s_waitcnt vmcnt(3)
    s_mov_b32 s34, 73728
    s_add_u32 m0, s36, 25344
    s_nop 0
    buffer_load_dwordx4 v10, s[20:23], s34 offen nt lds
    s_waitcnt vmcnt(3)
    s_mov_b64 exec, 1
    ds_add_u32 v12, v20 offset:1024
    s_mov_b64 exec, -1
    s_add_u32 m0, s36, 26400
    s_nop 0
    buffer_load_dwordx4 v11, s[20:23], s34 offen nt lds
    s_waitcnt vmcnt(3)
    s_mov_b32 s34, 90112
    s_add_u32 m0, s36, 33792
    s_nop 0
    buffer_load_dwordx4 v10, s[16:19], s34 offen nt lds
    s_waitcnt vmcnt(3)
    s_add_u32 m0, s36, 34848
    s_nop 0
    buffer_load_dwordx4 v11, s[16:19], s34 offen nt lds
    s_waitcnt vmcnt(3)
    s_mov_b32 s34, 81920
    s_add_u32 m0, s36, 42240
    s_nop 0
    buffer_load_dwordx4 v10, s[20:23], s34 offen nt lds
    s_waitcnt vmcnt(3)
    s_mov_b64 exec, 1
    ds_add_u32 v12, v20 offset:17920
    s_mov_b64 exec, -1
    s_add_u32 m0, s36, 43296
    s_nop 0
    buffer_load_dwordx4 v11, s[20:23], s34 offen nt lds
    s_waitcnt vmcnt(3)
L_lp12:
    ds_read_b128 v[16:19], v254
    s_waitcnt lgkmcnt(0)
    v_min3_u32 v16, v16, v17, v18
    v_min_u32 v16, v16, v19
    v_cmp_gt_u32 vcc, 8, v16
    s_cbranch_vccnz L_lp12_slp
    s_mov_b32 s34, 98304
    s_add_u32 m0, s36, 50688
    s_nop 0
    buffer_load_dwordx4 v10, s[16:19], s34 offen nt lds
    s_waitcnt vmcnt(3)
    s_add_u32 m0, s36, 51744
    s_nop 0
    buffer_load_dwordx4 v11, s[16:19], s34 offen nt lds
    s_waitcnt vmcnt(3)
    s_mov_b32 s34, 90112
    s_add_u32 m0, s36, 59136
    s_nop 0
    buffer_load_dwordx4 v10, s[20:23], s34 offen nt lds
    s_waitcnt vmcnt(3)
    s_mov_b64 exec, 1
    ds_add_u32 v12, v20 offset:34816
    s_mov_b64 exec, -1
    s_add_u32 m0, s36, 60192
    s_nop 0
    buffer_load_dwordx4 v11, s[20:23], s34 offen nt lds
    s_mov_b32 s34, 106496
    s_add_u32 m0, s36, 67584
    s_nop 0
    buffer_load_dwordx4 v10, s[16:19], s34 offen nt lds
    s_waitcnt vmcnt(4)
    s_add_u32 m0, s36, 68640
    s_nop 0
    buffer_load_dwordx4 v11, s[16:19], s34 offen nt lds
    s_waitcnt vmcnt(4)
    s_mov_b32 s34, 98304
    s_add_u32 m0, s36, 76032
    s_nop 0
    buffer_load_dwordx4 v10, s[20:23], s34 offen nt lds
    s_waitcnt vmcnt(4)
    s_add_u32 m0, s36, 77088
    s_nop 0
    buffer_load_dwordx4 v11, s[20:23], s34 offen nt lds
    s_waitcnt vmcnt(4)
    s_mov_b64 exec, 1
    ds_add_u32 v12, v20 offset:51712
    s_mov_b64 exec, -1
    s_mov_b32 s34, 114688
    s_add_u32 m0, s36, 84480
    s_nop 0
    buffer_load_dwordx4 v10, s[16:19], s34 offen nt lds
    s_waitcnt vmcnt(4)
    s_add_u32 m0, s36, 85536
    s_nop 0
    buffer_load_dwordx4 v11, s[16:19], s34 offen nt lds
    s_waitcnt vmcnt(4)
    s_mov_b32 s34, 106496
    s_add_u32 m0, s36, 92928
    s_nop 0
    buffer_load_dwordx4 v10, s[20:23], s34 offen nt lds
    s_waitcnt vmcnt(4)
    s_add_u32 m0, s36, 93984
    s_nop 0
    buffer_load_dwordx4 v11, s[20:23], s34 offen nt lds
    s_waitcnt vmcnt(4)
    s_mov_b64 exec, 1
    ds_add_u32 v13, v20 offset:1024
    s_mov_b64 exec, -1
    s_mov_b32 s34, 122880
    s_add_u32 m0, s36, 101376
    s_nop 0
    buffer_load_dwordx4 v10, s[16:19], s34 offen nt lds
    s_waitcnt vmcnt(4)
    s_add_u32 m0, s36, 102432
    s_nop 0
    buffer_load_dwordx4 v11, s[16:19], s34 offen nt lds
    s_waitcnt vmcnt(4)
    s_mov_b32 s34, 114688
    s_add_u32 m0, s36, 109824
    s_nop 0
    buffer_load_dwordx4 v10, s[20:23], s34 offen nt lds
    s_waitcnt vmcnt(4)
    s_add_u32 m0, s36, 110880
    s_nop 0
    buffer_load_dwordx4 v11, s[20:23], s34 offen nt lds
    s_waitcnt vmcnt(4)
    s_mov_b64 exec, 1
    ds_add_u32 v13, v20 offset:17920
    s_mov_b64 exec, -1
L_lp16:
    ds_read_b128 v[16:19], v254
    s_waitcnt lgkmcnt(0)
    v_min3_u32 v16, v16, v17, v18
    v_min_u32 v16, v16, v19
    v_cmp_gt_u32 vcc, 12, v16
    s_cbranch_vccnz L_lp16_slp
    s_mov_b32 s34, 131072
    s_add_u32 m0, s36, 118272
    s_nop 0
    buffer_load_dwordx4 v10, s[16:19], s34 offen nt lds
    s_waitcnt vmcnt(4)
    s_add_u32 m0, s36, 119328
    s_nop 0
    buffer_load_dwordx4 v11, s[16:19], s34 offen nt lds
    s_waitcnt vmcnt(4)
    s_mov_b32 s34, 122880
    s_add_u32 m0, s36, 126720
    s_nop 0
    buffer_load_dwordx4 v10, s[20:23], s34 offen nt lds
    s_waitcnt vmcnt(4)
    s_add_u32 m0, s36, 127776
    s_nop 0
    buffer_load_dwordx4 v11, s[20:23], s34 offen nt lds
    s_waitcnt vmcnt(4)
    s_mov_b64 exec, 1
    ds_add_u32 v13, v20 offset:34816
    s_mov_b64 exec, -1
    s_mov_b32 s34, 139264
    s_add_u32 m0, s36, 0
    s_nop 0
    buffer_load_dwordx4 v10, s[16:19], s34 offen nt lds
    s_waitcnt vmcnt(4)
    s_add_u32 m0, s36, 1056
    s_nop 0
    buffer_load_dwordx4 v11, s[16:19], s34 offen nt lds
    s_waitcnt vmcnt(4)
    s_mov_b32 s34, 131072
    s_add_u32 m0, s36, 8448
    s_nop 0
    buffer_load_dwordx4 v10, s[20:23], s34 offen nt lds
    s_waitcnt vmcnt(4)
    s_add_u32 m0, s36, 9504
    s_nop 0
    buffer_load_dwordx4 v11, s[20:23], s34 offen nt lds
    s_waitcnt vmcnt(4)
    s_mov_b64 exec, 1
    ds_add_u32 v13, v20 offset:51712
    s_mov_b64 exec, -1
    s_mov_b32 s34, 147456
    s_add_u32 m0, s36, 16896
    s_nop 0
    buffer_load_dwordx4 v10, s[16:19], s34 offen nt lds
    s_waitcnt vmcnt(4)
    s_add_u32 m0, s36, 17952
    s_nop 0
    buffer_load_dwordx4 v11, s[16:19], s34 offen nt lds
    s_waitcnt vmcnt(4)
    s_mov_b32 s34, 139264
    s_add_u32 m0, s36, 25344
    s_nop 0
    buffer_load_dwordx4 v10, s[20:23], s34 offen nt lds
    s_waitcnt vmcnt(4)
    s_add_u32 m0, s36, 26400
    s_nop 0
    buffer_load_dwordx4 v11, s[20:23], s34 offen nt lds
    s_waitcnt vmcnt(4)
    s_mov_b64 exec, 1
    ds_add_u32 v12, v20 offset:1024
    s_mov_b64 exec, -1
    s_mov_b32 s34, 155648
    s_add_u32 m0, s36, 33792
    s_nop 0
    buffer_load_dwordx4 v10, s[16:19], s34 offen nt lds
    s_waitcnt vmcnt(4)
    s_add_u32 m0, s36, 34848
    s_nop 0
    buffer_load_dwordx4 v11, s[16:19], s34 offen nt lds
    s_waitcnt vmcnt(4)
    s_mov_b32 s34, 147456
    s_add_u32 m0, s36, 42240
    s_nop 0
    buffer_load_dwordx4 v10, s[20:23], s34 offen nt lds
    s_waitcnt vmcnt(4)
    s_add_u32 m0, s36, 43296
    s_nop 0
    buffer_load_dwordx4 v11, s[20:23], s34 offen nt lds
    s_waitcnt vmcnt(4)
    s_mov_b64 exec, 1
    ds_add_u32 v12, v20 offset:17920
    s_mov_b64 exec, -1
L_lp20:
    ds_read_b128 v[16:19], v254
    s_waitcnt lgkmcnt(0)
    v_min3_u32 v16, v16, v17, v18
    v_min_u32 v16, v16, v19
    v_cmp_gt_u32 vcc, 16, v16
    s_cbranch_vccnz L_lp20_slp
    s_mov_b32 s34, 163840
    s_add_u32 m0, s36, 50688
    s_nop 0
    buffer_load_dwordx4 v10, s[16:19], s34 offen nt lds
    s_waitcnt vmcnt(4)
    s_add_u32 m0, s36, 51744
    s_nop 0
    buffer_load_dwordx4 v11, s[16:19], s34 offen nt lds
    s_waitcnt vmcnt(4)
    s_mov_b32 s34, 155648
    s_add_u32 m0, s36, 59136
    s_nop 0
    buffer_load_dwordx4 v10, s[20:23], s34 offen nt lds
    s_waitcnt vmcnt(4)
    s_add_u32 m0, s36, 60192
    s_nop 0
    buffer_load_dwordx4 v11, s[20:23], s34 offen nt lds
    s_waitcnt vmcnt(4)
    s_mov_b64 exec, 1
    ds_add_u32 v12, v20 offset:34816
    s_mov_b64 exec, -1
    s_mov_b32 s34, 172032
    s_add_u32 m0, s36, 67584
    s_nop 0
    buffer_load_dwordx4 v10, s[16:19], s34 offen nt lds
    s_waitcnt vmcnt(4)
    s_add_u32 m0, s36, 68640
    s_nop 0
    buffer_load_dwordx4 v11, s[16:19], s34 offen nt lds
    s_waitcnt vmcnt(4)
    s_mov_b32 s34, 163840
    s_add_u32 m0, s36, 76032
    s_nop 0
    buffer_load_dwordx4 v10, s[20:23], s34 offen nt lds
    s_waitcnt vmcnt(4)
    s_add_u32 m0, s36, 77088
    s_nop 0
    buffer_load_dwordx4 v11, s[20:23], s34 offen nt lds
    s_waitcnt vmcnt(4)
    s_mov_b64 exec, 1
    ds_add_u32 v12, v20 offset:51712
    s_mov_b64 exec, -1
    s_mov_b32 s34, 180224
    s_add_u32 m0, s36, 84480
    s_nop 0
    buffer_load_dwordx4 v10, s[16:19], s34 offen nt lds
    s_waitcnt vmcnt(4)
    s_add_u32 m0, s36, 85536
    s_nop 0
    buffer_load_dwordx4 v11, s[16:19], s34 offen nt lds
    s_waitcnt vmcnt(4)
    s_mov_b32 s34, 172032
    s_add_u32 m0, s36, 92928
    s_nop 0
    buffer_load_dwordx4 v10, s[20:23], s34 offen nt lds
    s_waitcnt vmcnt(4)
    s_add_u32 m0, s36, 93984
    s_nop 0
    buffer_load_dwordx4 v11, s[20:23], s34 offen nt lds
    s_waitcnt vmcnt(4)
    s_mov_b64 exec, 1
    ds_add_u32 v13, v20 offset:1024
    s_mov_b64 exec, -1
    s_mov_b32 s34, 188416
    s_add_u32 m0, s36, 101376
    s_nop 0
    buffer_load_dwordx4 v10, s[16:19], s34 offen nt lds
    s_waitcnt vmcnt(4)
    s_add_u32 m0, s36, 102432
    s_nop 0
    buffer_load_dwordx4 v11, s[16:19], s34 offen nt lds
    s_waitcnt vmcnt(4)
    s_mov_b32 s34, 180224
    s_add_u32 m0, s36, 109824
    s_nop 0
    buffer_load_dwordx4 v10, s[20:23], s34 offen nt lds
    s_waitcnt vmcnt(4)
    s_add_u32 m0, s36, 110880
    s_nop 0
    buffer_load_dwordx4 v11, s[20:23], s34 offen nt lds
    s_waitcnt vmcnt(4)
    s_mov_b64 exec, 1
    ds_add_u32 v13, v20 offset:17920
    s_mov_b64 exec, -1
L_lp24:
    ds_read_b128 v[16:19], v254
    s_waitcnt lgkmcnt(0)
    v_min3_u32 v16, v16, v17, v18
    v_min_u32 v16, v16, v19
    v_cmp_gt_u32 vcc, 20, v16
    s_cbranch_vccnz L_lp24_slp
    s_mov_b32 s34, 196608
    s_add_u32 m0, s36, 118272
    s_nop 0
    buffer_load_dwordx4 v10, s[16:19], s34 offen nt lds
    s_waitcnt vmcnt(4)
    s_add_u32 m0, s36, 119328
    s_nop 0
    buffer_load_dwordx4 v11, s[16:19], s34 offen nt lds
    s_waitcnt vmcnt(4)
    s_mov_b32 s34, 188416
    s_add_u32 m0, s36, 126720
    s_nop 0
    buffer_load_dwordx4 v10, s[20:23], s34 offen nt lds
    s_waitcnt vmcnt(4)
    s_add_u32 m0, s36, 127776
    s_nop 0
    buffer_load_dwordx4 v11, s[20:23], s34 offen nt lds
    s_waitcnt vmcnt(4)
    s_mov_b64 exec, 1
    ds_add_u32 v13, v20 offset:34816
    s_mov_b64 exec, -1
    s_mov_b32 s34, 204800
    s_add_u32 m0, s36, 0
    s_nop 0
    buffer_load_dwordx4 v10, s[16:19], s34 offen nt lds
    s_waitcnt vmcnt(4)
    s_add_u32 m0, s36, 1056
    s_nop 0
    buffer_load_dwordx4 v11, s[16:19], s34 offen nt lds
    s_waitcnt vmcnt(4)
    s_mov_b32 s34, 196608
    s_add_u32 m0, s36, 8448
    s_nop 0
    buffer_load_dwordx4 v10, s[20:23], s34 offen nt lds
    s_waitcnt vmcnt(4)
    s_add_u32 m0, s36, 9504
    s_nop 0
    buffer_load_dwordx4 v11, s[20:23], s34 offen nt lds
    s_waitcnt vmcnt(4)
    s_mov_b64 exec, 1
    ds_add_u32 v13, v20 offset:51712
    s_mov_b64 exec, -1
    s_mov_b32 s34, 212992
    s_add_u32 m0, s36, 16896
    s_nop 0
    buffer_load_dwordx4 v10, s[16:19], s34 offen nt lds
    s_waitcnt vmcnt(4)
    s_add_u32 m0, s36, 17952
    s_nop 0
    buffer_load_dwordx4 v11, s[16:19], s34 offen nt lds
    s_waitcnt vmcnt(4)
    s_mov_b32 s34, 204800
    s_add_u32 m0, s36, 25344
    s_nop 0
    buffer_load_dwordx4 v10, s[20:23], s34 offen nt lds
    s_waitcnt vmcnt(4)
    s_add_u32 m0, s36, 26400
    s_nop 0
    buffer_load_dwordx4 v11, s[20:23], s34 offen nt lds
    s_waitcnt vmcnt(4)
    s_mov_b64 exec, 1
    ds_add_u32 v12, v20 offset:1024
    s_mov_b64 exec, -1
    s_mov_b32 s34, 221184
    s_add_u32 m0, s36, 33792
    s_nop 0
    buffer_load_dwordx4 v10, s[16:19], s34 offen nt lds
    s_waitcnt vmcnt(4)
    s_add_u32 m0, s36, 34848
    s_nop 0
    buffer_load_dwordx4 v11, s[16:19], s34 offen nt lds
    s_waitcnt vmcnt(4)
    s_mov_b32 s34, 212992
    s_add_u32 m0, s36, 42240
    s_nop 0
    buffer_load_dwordx4 v10, s[20:23], s34 offen nt lds
    s_waitcnt vmcnt(4)
    s_add_u32 m0, s36, 43296
    s_nop 0
    buffer_load_dwordx4 v11, s[20:23], s34 offen nt lds
    s_waitcnt vmcnt(4)
    s_mov_b64 exec, 1
    ds_add_u32 v12, v20 offset:17920
    s_mov_b64 exec, -1
L_lp28:
    ds_read_b128 v[16:19], v254
    s_waitcnt lgkmcnt(0)
    v_min3_u32 v16, v16, v17, v18
    v_min_u32 v16, v16, v19
    v_cmp_gt_u32 vcc, 24, v16
    s_cbranch_vccnz L_lp28_slp
    s_mov_b32 s34, 229376
    s_add_u32 m0, s36, 50688
    s_nop 0
    buffer_load_dwordx4 v10, s[16:19], s34 offen nt lds
    s_waitcnt vmcnt(4)
    s_add_u32 m0, s36, 51744
    s_nop 0
    buffer_load_dwordx4 v11, s[16:19], s34 offen nt lds
    s_waitcnt vmcnt(4)
    s_mov_b32 s34, 221184
    s_add_u32 m0, s36, 59136
    s_nop 0
    buffer_load_dwordx4 v10, s[20:23], s34 offen nt lds
    s_waitcnt vmcnt(4)
    s_add_u32 m0, s36, 60192
    s_nop 0
    buffer_load_dwordx4 v11, s[20:23], s34 offen nt lds
    s_waitcnt vmcnt(4)
    s_mov_b64 exec, 1
    ds_add_u32 v12, v20 offset:34816
    s_mov_b64 exec, -1
    s_mov_b32 s34, 237568
    s_add_u32 m0, s36, 67584
    s_nop 0
    buffer_load_dwordx4 v10, s[16:19], s34 offen nt lds
    s_waitcnt vmcnt(4)
    s_add_u32 m0, s36, 68640
    s_nop 0
    buffer_load_dwordx4 v11, s[16:19], s34 offen nt lds
    s_waitcnt vmcnt(4)
    s_mov_b32 s34, 229376
    s_add_u32 m0, s36, 76032
    s_nop 0
    buffer_load_dwordx4 v10, s[20:23], s34 offen nt lds
    s_waitcnt vmcnt(4)
    s_add_u32 m0, s36, 77088
    s_nop 0
    buffer_load_dwordx4 v11, s[20:23], s34 offen nt lds
    s_waitcnt vmcnt(4)
    s_mov_b64 exec, 1
    ds_add_u32 v12, v20 offset:51712
    s_mov_b64 exec, -1
    s_mov_b32 s34, 245760
    s_add_u32 m0, s36, 84480
    s_nop 0
    buffer_load_dwordx4 v10, s[16:19], s34 offen nt lds
    s_waitcnt vmcnt(4)
    s_add_u32 m0, s36, 85536
    s_nop 0
    buffer_load_dwordx4 v11, s[16:19], s34 offen nt lds
    s_waitcnt vmcnt(4)
    s_mov_b32 s34, 237568
    s_add_u32 m0, s36, 92928
    s_nop 0
    buffer_load_dwordx4 v10, s[20:23], s34 offen nt lds
    s_waitcnt vmcnt(4)
    s_add_u32 m0, s36, 93984
    s_nop 0
    buffer_load_dwordx4 v11, s[20:23], s34 offen nt lds
    s_waitcnt vmcnt(4)
    s_mov_b64 exec, 1
    ds_add_u32 v13, v20 offset:1024
    s_mov_b64 exec, -1
    s_mov_b32 s34, 253952
    s_add_u32 m0, s36, 101376
    s_nop 0
    buffer_load_dwordx4 v10, s[16:19], s34 offen nt lds
    s_waitcnt vmcnt(4)
    s_add_u32 m0, s36, 102432
    s_nop 0
    buffer_load_dwordx4 v11, s[16:19], s34 offen nt lds
    s_waitcnt vmcnt(4)
    s_mov_b32 s34, 245760
    s_add_u32 m0, s36, 109824
    s_nop 0
    buffer_load_dwordx4 v10, s[20:23], s34 offen nt lds
    s_waitcnt vmcnt(4)
    s_add_u32 m0, s36, 110880
    s_nop 0
    buffer_load_dwordx4 v11, s[20:23], s34 offen nt lds
    s_waitcnt vmcnt(4)
    s_mov_b64 exec, 1
    ds_add_u32 v13, v20 offset:17920
    s_mov_b64 exec, -1
L_lp32:
    ds_read_b128 v[16:19], v254
    s_waitcnt lgkmcnt(0)
    v_min3_u32 v16, v16, v17, v18
    v_min_u32 v16, v16, v19
    v_cmp_gt_u32 vcc, 25, v16
    s_cbranch_vccnz L_lp32_slp
    s_mov_b32 s34, 253952
    s_add_u32 m0, s36, 126720
    s_nop 0
    buffer_load_dwordx4 v10, s[20:23], s34 offen nt lds
    s_waitcnt vmcnt(4)
    s_add_u32 m0, s36, 127776
    s_nop 0
    buffer_load_dwordx4 v11, s[20:23], s34 offen nt lds
    s_waitcnt vmcnt(2)
    s_mov_b64 exec, 1
    ds_add_u32 v13, v20 offset:34816
    s_mov_b64 exec, -1
    s_waitcnt vmcnt(0)
    s_mov_b64 exec, 1
    ds_add_u32 v13, v20 offset:51712
    s_mov_b64 exec, -1
    s_waitcnt lgkmcnt(0)
L_end:
    s_endpgm
L_lp5_slp:
    s_sleep 2
    s_branch L_lp5
L_lp8_slp:
    s_sleep 2
    s_branch L_lp8
L_lp12_slp:
    s_sleep 2
    s_branch L_lp12
L_lp16_slp:
    s_sleep 2
    s_branch L_lp16
L_lp20_slp:
    s_sleep 2
    s_branch L_lp20
L_lp24_slp:
    s_sleep 2
    s_branch L_lp24
L_lp28_slp:
    s_sleep 2
    s_branch L_lp28
L_lp32_slp:
    s_sleep 2
    s_branch L_lp32
    .p2align 6
L_compute:
    v_lshlrev_b32_e64 v1, 2, v1
    v_lshl_add_u32 v1, v0, 4, v1
    v_add_u32 v255, 135168, v1
    v_mov_b32_e64 v254, 0
    ds_write_b32 v255, v254
    s_mov_b32 s26, 49152
    s_mov_b32 s27, 0x00020000
    s_mov_b32 s32, 4096
    s_mov_b32 s33, 8192
    s_waitcnt lgkmcnt(0)
    s_barrier
    s_add_u32 s24, s10, s37
    s_addc_u32 s25, s11, 0
    s_and_b32 s25, s25, 0xffff
    s_mov_b32 s29, 0x3e0293ee
    s_mov_b32 s30, 0x41000000
    s_mov_b32 s39, 67584
    s_mov_b32 s3, 4
    s_mov_b32 s47, 4
    s_mov_b32 s38, 1056
    v_and_b32_e64 v5, 7, v2
    v_mul_u32_u24_e64 v5, s38, v5
    v_lshrrev_b32_e64 v6, 3, v2
    v_lshl_add_u32 v5, v6, 8, v5
    v_lshl_add_u32 v5, v3, 4, v5
    v_add_u32 v252, 67584, v5
    v_lshrrev_b32_e64 v8, 2, v2
    v_lshl_add_u32 v8, v3, 2, v8
    v_and_b32_e64 v9, 7, v8
    v_mul_u32_u24_e64 v9, s38, v9
    v_lshrrev_b32_e64 v8, 3, v8
    v_lshl_add_u32 v9, v8, 8, v9
    v_and_b32_e64 v8, 3, v0
    v_lshl_add_u32 v253, v8, 3, v9
    s_mul_i32 s34, s28, 3
    s_add_u32 s34, s34, 0
    s_lshr_b32 s35, s34, 1
    s_mul_i32 s35, s35, 8448
    s_and_b32 s34, s34, 1
    s_lshl_b32 s34, s34, 9
    s_add_u32 s34, s34, s35
    v_add_u32_e32 v198, s34, v252
    s_mul_i32 s34, s28, 3
    s_add_u32 s34, s34, 1
    s_lshr_b32 s35, s34, 1
    s_mul_i32 s35, s35, 8448
    s_and_b32 s34, s34, 1
    s_lshl_b32 s34, s34, 9
    s_add_u32 s34, s34, s35
    v_add_u32_e32 v199, s34, v252
    s_mul_i32 s34, s28, 3
    s_add_u32 s34, s34, 2
    s_lshr_b32 s35, s34, 1
    s_mul_i32 s35, s35, 8448
    s_and_b32 s34, s34, 1
    s_lshl_b32 s34, s34, 9
    s_add_u32 s34, s34, s35
    v_add_u32_e64 v200, s34, v252
    v_mov_b32_e64 v0, 0
    v_mov_b32_e64 v1, 0
    v_mov_b32_e64 v2, 0
    v_mov_b32_e64 v3, 0
    v_mov_b32_e64 v4, 0
    v_mov_b32_e64 v5, 0
    v_mov_b32_e64 v6, 0
    v_mov_b32_e64 v7, 0
    v_mov_b32_e64 v8, 0
    v_mov_b32_e64 v9, 0
    v_mov_b32_e64 v10, 0
    v_mov_b32_e64 v11, 0
    v_mov_b32_e64 v12, 0
    v_mov_b32_e64 v13, 0
    v_mov_b32_e64 v14, 0
    v_mov_b32_e64 v15, 0
    v_mov_b32_e64 v16, 0
    v_mov_b32_e64 v17, 0
    v_mov_b32_e64 v18, 0
    v_mov_b32_e64 v19, 0
    v_mov_b32_e64 v20, 0
    v_mov_b32_e64 v21, 0
    v_mov_b32_e64 v22, 0
    v_mov_b32_e64 v23, 0
    v_mov_b32_e64 v24, 0
    v_mov_b32_e64 v25, 0
    v_mov_b32_e64 v26, 0
    v_mov_b32_e64 v27, 0
    v_mov_b32_e64 v28, 0
    v_mov_b32_e64 v29, 0
    v_mov_b32_e64 v30, 0
    v_mov_b32_e64 v31, 0
    v_mov_b32_e64 v32, 0
    v_mov_b32_e64 v33, 0
    v_mov_b32_e64 v34, 0
    v_mov_b32_e64 v35, 0
    v_mov_b32_e64 v36, 0
    v_mov_b32_e64 v37, 0
    v_mov_b32_e64 v38, 0
    v_mov_b32_e64 v39, 0
    v_mov_b32_e64 v40, 0
    v_mov_b32_e64 v41, 0
    v_mov_b32_e64 v42, 0
    v_mov_b32_e64 v43, 0
    v_mov_b32_e64 v44, 0
    v_mov_b32_e64 v45, 0
    v_mov_b32_e64 v46, 0
    v_mov_b32_e64 v47, 0
    v_mov_b32_e64 v48, 0
    v_mov_b32_e64 v49, 0
    v_mov_b32_e64 v50, 0
    v_mov_b32_e64 v51, 0
    v_mov_b32_e64 v52, 0
    v_mov_b32_e64 v53, 0
    v_mov_b32_e64 v54, 0
    v_mov_b32_e64 v55, 0
    v_mov_b32_e64 v56, 0
    v_mov_b32_e64 v57, 0
    v_mov_b32_e64 v58, 0
    v_mov_b32_e64 v59, 0
    v_mov_b32_e64 v60, 0
    v_mov_b32_e64 v61, 0
    v_mov_b32_e64 v62, 0
    v_mov_b32_e64 v63, 0
    v_mov_b32_e64 v64, 0
    v_mov_b32_e64 v65, 0
    v_mov_b32_e64 v66, 0
    v_mov_b32_e64 v67, 0
    v_mov_b32_e64 v68, 0
    v_mov_b32_e64 v69, 0
    v_mov_b32_e64 v70, 0
    v_mov_b32_e64 v71, 0
    v_mov_b32_e64 v72, 0
    v_mov_b32_e64 v73, 0
    v_mov_b32_e64 v74, 0
    v_mov_b32_e64 v75, 0
    v_mov_b32_e64 v76, 0
    v_mov_b32_e64 v77, 0
    v_mov_b32_e64 v78, 0
    v_mov_b32_e64 v79, 0
    v_mov_b32_e64 v80, 0
    v_mov_b32_e64 v81, 0
    v_mov_b32_e64 v82, 0
    v_mov_b32_e64 v83, 0
    v_mov_b32_e64 v84, 0
    v_mov_b32_e64 v85, 0
    v_mov_b32_e64 v86, 0
    v_mov_b32_e64 v87, 0
    v_mov_b32_e64 v88, 0
    v_mov_b32_e64 v89, 0
    v_mov_b32_e64 v90, 0
    v_mov_b32_e64 v91, 0
    v_mov_b32_e64 v92, 0
    v_mov_b32_e64 v93, 0
    v_mov_b32_e64 v94, 0
    v_mov_b32_e64 v95, 0
    v_mov_b32_e64 v224, 0
    v_mov_b32_e64 v225, 0
    v_mov_b32_e64 v226, 0
    v_mov_b32_e64 v227, 0
    v_mov_b32_e64 v228, 0
    v_mov_b32_e64 v229, 0
    v_mov_b32_e64 v230, 0
    v_mov_b32_e64 v231, 0
    v_mov_b32_e64 v232, 0
    v_mov_b32_e64 v233, 0
    v_mov_b32_e64 v234, 0
    v_mov_b32_e64 v235, 0
    v_mov_b32 v236, 0x3f803f80
    v_mov_b32 v237, 0x3f803f80
    v_mov_b32 v238, 0x3f803f80
    v_mov_b32 v239, 0x3f803f80
    s_mul_i32 s31, s28, 1056
    v_mov_b32_e64 v254, s31
    ds_read_b32 v194, v254 offset:2080
    s_waitcnt lgkmcnt(0)
    v_cmp_gt_u32_e32 vcc, s47, v194
    s_cbranch_vccnz L_w0
L_w0_ret:
    v_mov_b32_e32 v254, 0
    ds_read_b128 v[96:99], v198 offset:0
    ds_read_b128 v[112:115], v199 offset:0
    ds_read_b128 v[128:131], v200 offset:0
    ds_read_b128 v[100:103], v198 offset:64
    ds_read_b128 v[116:119], v199 offset:64
    ds_read_b128 v[132:135], v200 offset:64
    ds_read_b128 v[104:107], v198 offset:128
    ds_read_b128 v[120:123], v199 offset:128
    ds_read_b128 v[136:139], v200 offset:128
    ds_read_b128 v[108:111], v198 offset:192
    ds_read_b128 v[124:127], v199 offset:192
    ds_read_b128 v[140:143], v200 offset:192
    s_waitcnt lgkmcnt(11)
    v_lshlrev_b32_e32 v168, 16, v96
    v_and_b32 v169, 0xffff0000, v96
    v_mul_f32_e64 v168, s29, v168
    v_mul_f32_e64 v169, s29, v169
    v_cvt_pk_bf16_f32 v96, v168, v169
    v_lshlrev_b32_e64 v170, 16, v97
    v_and_b32 v171, 0xffff0000, v97
    v_mul_f32_e64 v170, s29, v170
    v_mul_f32_e64 v171, s29, v171
    v_cvt_pk_bf16_f32 v97, v170, v171
    v_lshlrev_b32_e64 v172, 16, v98
    v_and_b32 v173, 0xffff0000, v98
    v_mul_f32_e64 v172, s29, v172
    v_mul_f32_e64 v173, s29, v173
    v_cvt_pk_bf16_f32 v98, v172, v173
    v_lshlrev_b32_e64 v174, 16, v99
    v_and_b32 v175, 0xffff0000, v99
    v_mul_f32_e64 v174, s29, v174
    v_mul_f32_e64 v175, s29, v175
    v_cvt_pk_bf16_f32 v99, v174, v175
    s_waitcnt lgkmcnt(10)
    v_lshlrev_b32_e32 v176, 16, v112
    v_and_b32 v177, 0xffff0000, v112
    v_mul_f32_e64 v176, s29, v176
    v_mul_f32_e64 v177, s29, v177
    v_cvt_pk_bf16_f32 v112, v176, v177
    v_lshlrev_b32_e64 v178, 16, v113
    v_and_b32 v179, 0xffff0000, v113
    v_mul_f32_e64 v178, s29, v178
    v_mul_f32_e64 v179, s29, v179
    v_cvt_pk_bf16_f32 v113, v178, v179
    v_lshlrev_b32_e64 v180, 16, v114
    v_and_b32 v181, 0xffff0000, v114
    v_mul_f32_e64 v180, s29, v180
    v_mul_f32_e64 v181, s29, v181
    v_cvt_pk_bf16_f32 v114, v180, v181
    v_lshlrev_b32_e64 v182, 16, v115
    v_and_b32 v183, 0xffff0000, v115
    v_mul_f32_e64 v182, s29, v182
    v_mul_f32_e64 v183, s29, v183
    v_cvt_pk_bf16_f32 v115, v182, v183
    s_waitcnt lgkmcnt(9)
    v_lshlrev_b32_e32 v168, 16, v128
    v_and_b32 v169, 0xffff0000, v128
    v_mul_f32_e64 v168, s29, v168
    v_mul_f32_e64 v169, s29, v169
    v_cvt_pk_bf16_f32 v128, v168, v169
    v_lshlrev_b32_e64 v170, 16, v129
    v_and_b32 v171, 0xffff0000, v129
    v_mul_f32_e64 v170, s29, v170
    v_mul_f32_e64 v171, s29, v171
    v_cvt_pk_bf16_f32 v129, v170, v171
    v_lshlrev_b32_e64 v172, 16, v130
    v_and_b32 v173, 0xffff0000, v130
    v_mul_f32_e64 v172, s29, v172
    v_mul_f32_e64 v173, s29, v173
    v_cvt_pk_bf16_f32 v130, v172, v173
    v_lshlrev_b32_e64 v174, 16, v131
    v_and_b32 v175, 0xffff0000, v131
    v_mul_f32_e64 v174, s29, v174
    v_mul_f32_e64 v175, s29, v175
    v_cvt_pk_bf16_f32 v131, v174, v175
    s_waitcnt lgkmcnt(8)
    v_lshlrev_b32_e32 v176, 16, v100
    v_and_b32 v177, 0xffff0000, v100
    v_mul_f32_e64 v176, s29, v176
    v_mul_f32_e64 v177, s29, v177
    v_cvt_pk_bf16_f32 v100, v176, v177
    v_lshlrev_b32_e64 v178, 16, v101
    v_and_b32 v179, 0xffff0000, v101
    v_mul_f32_e64 v178, s29, v178
    v_mul_f32_e64 v179, s29, v179
    v_cvt_pk_bf16_f32 v101, v178, v179
    v_lshlrev_b32_e64 v180, 16, v102
    v_and_b32 v181, 0xffff0000, v102
    v_mul_f32_e64 v180, s29, v180
    v_mul_f32_e64 v181, s29, v181
    v_cvt_pk_bf16_f32 v102, v180, v181
    v_lshlrev_b32_e64 v182, 16, v103
    v_and_b32 v183, 0xffff0000, v103
    v_mul_f32_e64 v182, s29, v182
    v_mul_f32_e64 v183, s29, v183
    v_cvt_pk_bf16_f32 v103, v182, v183
    s_waitcnt lgkmcnt(7)
    v_lshlrev_b32_e32 v168, 16, v116
    v_and_b32 v169, 0xffff0000, v116
    v_mul_f32_e64 v168, s29, v168
    v_mul_f32_e64 v169, s29, v169
    v_cvt_pk_bf16_f32 v116, v168, v169
    v_lshlrev_b32_e64 v170, 16, v117
    v_and_b32 v171, 0xffff0000, v117
    v_mul_f32_e64 v170, s29, v170
    v_mul_f32_e64 v171, s29, v171
    v_cvt_pk_bf16_f32 v117, v170, v171
    v_lshlrev_b32_e64 v172, 16, v118
    v_and_b32 v173, 0xffff0000, v118
    v_mul_f32_e64 v172, s29, v172
    v_mul_f32_e64 v173, s29, v173
    v_cvt_pk_bf16_f32 v118, v172, v173
    v_lshlrev_b32_e64 v174, 16, v119
    v_and_b32 v175, 0xffff0000, v119
    v_mul_f32_e64 v174, s29, v174
    v_mul_f32_e64 v175, s29, v175
    v_cvt_pk_bf16_f32 v119, v174, v175
    s_waitcnt lgkmcnt(6)
    v_lshlrev_b32_e32 v176, 16, v132
    v_and_b32 v177, 0xffff0000, v132
    v_mul_f32_e64 v176, s29, v176
    v_mul_f32_e64 v177, s29, v177
    v_cvt_pk_bf16_f32 v132, v176, v177
    v_lshlrev_b32_e64 v178, 16, v133
    v_and_b32 v179, 0xffff0000, v133
    v_mul_f32_e64 v178, s29, v178
    v_mul_f32_e64 v179, s29, v179
    v_cvt_pk_bf16_f32 v133, v178, v179
    v_lshlrev_b32_e64 v180, 16, v134
    v_and_b32 v181, 0xffff0000, v134
    v_mul_f32_e64 v180, s29, v180
    v_mul_f32_e64 v181, s29, v181
    v_cvt_pk_bf16_f32 v134, v180, v181
    v_lshlrev_b32_e64 v182, 16, v135
    v_and_b32 v183, 0xffff0000, v135
    v_mul_f32_e64 v182, s29, v182
    v_mul_f32_e64 v183, s29, v183
    v_cvt_pk_bf16_f32 v135, v182, v183
    s_waitcnt lgkmcnt(5)
    v_lshlrev_b32_e32 v168, 16, v104
    v_and_b32 v169, 0xffff0000, v104
    v_mul_f32_e64 v168, s29, v168
    v_mul_f32_e64 v169, s29, v169
    v_cvt_pk_bf16_f32 v104, v168, v169
    v_lshlrev_b32_e64 v170, 16, v105
    v_and_b32 v171, 0xffff0000, v105
    v_mul_f32_e64 v170, s29, v170
    v_mul_f32_e64 v171, s29, v171
    v_cvt_pk_bf16_f32 v105, v170, v171
    v_lshlrev_b32_e64 v172, 16, v106
    v_and_b32 v173, 0xffff0000, v106
    v_mul_f32_e64 v172, s29, v172
    v_mul_f32_e64 v173, s29, v173
    v_cvt_pk_bf16_f32 v106, v172, v173
    v_lshlrev_b32_e64 v174, 16, v107
    v_and_b32 v175, 0xffff0000, v107
    v_mul_f32_e64 v174, s29, v174
    v_mul_f32_e64 v175, s29, v175
    v_cvt_pk_bf16_f32 v107, v174, v175
    s_waitcnt lgkmcnt(4)
    v_lshlrev_b32_e32 v176, 16, v120
    v_and_b32 v177, 0xffff0000, v120
    v_mul_f32_e64 v176, s29, v176
    v_mul_f32_e64 v177, s29, v177
    v_cvt_pk_bf16_f32 v120, v176, v177
    v_lshlrev_b32_e64 v178, 16, v121
    v_and_b32 v179, 0xffff0000, v121
    v_mul_f32_e64 v178, s29, v178
    v_mul_f32_e64 v179, s29, v179
    v_cvt_pk_bf16_f32 v121, v178, v179
    v_lshlrev_b32_e64 v180, 16, v122
    v_and_b32 v181, 0xffff0000, v122
    v_mul_f32_e64 v180, s29, v180
    v_mul_f32_e64 v181, s29, v181
    v_cvt_pk_bf16_f32 v122, v180, v181
    v_lshlrev_b32_e64 v182, 16, v123
    v_and_b32 v183, 0xffff0000, v123
    v_mul_f32_e64 v182, s29, v182
    v_mul_f32_e64 v183, s29, v183
    v_cvt_pk_bf16_f32 v123, v182, v183
    s_waitcnt lgkmcnt(3)
    v_lshlrev_b32_e32 v168, 16, v136
    v_and_b32 v169, 0xffff0000, v136
    v_mul_f32_e64 v168, s29, v168
    v_mul_f32_e64 v169, s29, v169
    v_cvt_pk_bf16_f32 v136, v168, v169
    v_lshlrev_b32_e64 v170, 16, v137
    v_and_b32 v171, 0xffff0000, v137
    v_mul_f32_e64 v170, s29, v170
    v_mul_f32_e64 v171, s29, v171
    v_cvt_pk_bf16_f32 v137, v170, v171
    v_lshlrev_b32_e64 v172, 16, v138
    v_and_b32 v173, 0xffff0000, v138
    v_mul_f32_e64 v172, s29, v172
    v_mul_f32_e64 v173, s29, v173
    v_cvt_pk_bf16_f32 v138, v172, v173
    v_lshlrev_b32_e64 v174, 16, v139
    v_and_b32 v175, 0xffff0000, v139
    v_mul_f32_e64 v174, s29, v174
    v_mul_f32_e64 v175, s29, v175
    v_cvt_pk_bf16_f32 v139, v174, v175
    s_waitcnt lgkmcnt(2)
    v_lshlrev_b32_e32 v176, 16, v108
    v_and_b32 v177, 0xffff0000, v108
    v_mul_f32_e64 v176, s29, v176
    v_mul_f32_e64 v177, s29, v177
    v_cvt_pk_bf16_f32 v108, v176, v177
    v_lshlrev_b32_e64 v178, 16, v109
    v_and_b32 v179, 0xffff0000, v109
    v_mul_f32_e64 v178, s29, v178
    v_mul_f32_e64 v179, s29, v179
    v_cvt_pk_bf16_f32 v109, v178, v179
    v_lshlrev_b32_e64 v180, 16, v110
    v_and_b32 v181, 0xffff0000, v110
    v_mul_f32_e64 v180, s29, v180
    v_mul_f32_e64 v181, s29, v181
    v_cvt_pk_bf16_f32 v110, v180, v181
    v_lshlrev_b32_e64 v182, 16, v111
    v_and_b32 v183, 0xffff0000, v111
    v_mul_f32_e64 v182, s29, v182
    v_mul_f32_e64 v183, s29, v183
    v_cvt_pk_bf16_f32 v111, v182, v183
    s_waitcnt lgkmcnt(1)
    v_lshlrev_b32_e32 v168, 16, v124
    v_and_b32 v169, 0xffff0000, v124
    v_mul_f32_e64 v168, s29, v168
    v_mul_f32_e64 v169, s29, v169
    v_cvt_pk_bf16_f32 v124, v168, v169
    v_lshlrev_b32_e64 v170, 16, v125
    v_and_b32 v171, 0xffff0000, v125
    v_mul_f32_e64 v170, s29, v170
    v_mul_f32_e64 v171, s29, v171
    v_cvt_pk_bf16_f32 v125, v170, v171
    v_lshlrev_b32_e64 v172, 16, v126
    v_and_b32 v173, 0xffff0000, v126
    v_mul_f32_e64 v172, s29, v172
    v_mul_f32_e64 v173, s29, v173
    v_cvt_pk_bf16_f32 v126, v172, v173
    v_lshlrev_b32_e64 v174, 16, v127
    v_and_b32 v175, 0xffff0000, v127
    v_mul_f32_e64 v174, s29, v174
    v_mul_f32_e64 v175, s29, v175
    v_cvt_pk_bf16_f32 v127, v174, v175
    s_waitcnt lgkmcnt(0)
    v_lshlrev_b32_e32 v176, 16, v140
    v_and_b32 v177, 0xffff0000, v140
    v_mul_f32_e64 v176, s29, v176
    v_mul_f32_e64 v177, s29, v177
    v_cvt_pk_bf16_f32 v140, v176, v177
    v_lshlrev_b32_e64 v178, 16, v141
    v_and_b32 v179, 0xffff0000, v141
    v_mul_f32_e64 v178, s29, v178
    v_mul_f32_e64 v179, s29, v179
    v_cvt_pk_bf16_f32 v141, v178, v179
    v_lshlrev_b32_e64 v180, 16, v142
    v_and_b32 v181, 0xffff0000, v142
    v_mul_f32_e64 v180, s29, v180
    v_mul_f32_e64 v181, s29, v181
    v_cvt_pk_bf16_f32 v142, v180, v181
    v_lshlrev_b32_e64 v182, 16, v143
    v_and_b32 v183, 0xffff0000, v143
    v_mul_f32_e64 v182, s29, v182
    v_mul_f32_e64 v183, s29, v183
    v_cvt_pk_bf16_f32 v143, v182, v183
    ds_read_b128 v[192:195], v252 offset:50688
    ds_read_b128 v[196:199], v252 offset:50752
    ds_read_b128 v[200:203], v252 offset:50816
    ds_read_b128 v[204:207], v252 offset:50880
    s_waitcnt lgkmcnt(2)
    v_mfma_f32_16x16x32_bf16 v[144:147], v[192:195], v[96:99], 0
    v_mfma_f32_16x16x32_bf16 v[152:155], v[192:195], v[112:115], 0
    v_mfma_f32_16x16x32_bf16 v[160:163], v[192:195], v[128:131], 0
    ds_read_b128 v[192:195], v252 offset:51200
    v_mfma_f32_16x16x32_bf16 v[144:147], v[196:199], v[100:103], v[144:147]
    v_mfma_f32_16x16x32_bf16 v[152:155], v[196:199], v[116:119], v[152:155]
    v_mfma_f32_16x16x32_bf16 v[160:163], v[196:199], v[132:135], v[160:163]
    ds_read_b128 v[196:199], v252 offset:51264
    s_waitcnt lgkmcnt(2)
    v_mfma_f32_16x16x32_bf16 v[144:147], v[200:203], v[104:107], v[144:147]
    v_mfma_f32_16x16x32_bf16 v[152:155], v[200:203], v[120:123], v[152:155]
    v_mfma_f32_16x16x32_bf16 v[160:163], v[200:203], v[136:139], v[160:163]
    ds_read_b128 v[200:203], v252 offset:51328
    v_mfma_f32_16x16x32_bf16 v[144:147], v[204:207], v[108:111], v[144:147]
    v_mfma_f32_16x16x32_bf16 v[152:155], v[204:207], v[124:127], v[152:155]
    v_mfma_f32_16x16x32_bf16 v[160:163], v[204:207], v[140:143], v[160:163]
    ds_read_b128 v[204:207], v252 offset:51392
    s_waitcnt lgkmcnt(2)
    v_mfma_f32_16x16x32_bf16 v[148:151], v[192:195], v[96:99], 0
    v_mfma_f32_16x16x32_bf16 v[156:159], v[192:195], v[112:115], 0
    v_mfma_f32_16x16x32_bf16 v[164:167], v[192:195], v[128:131], 0
    v_mfma_f32_16x16x32_bf16 v[148:151], v[196:199], v[100:103], v[148:151]
    v_mfma_f32_16x16x32_bf16 v[156:159], v[196:199], v[116:119], v[156:159]
    v_mfma_f32_16x16x32_bf16 v[164:167], v[196:199], v[132:135], v[164:167]
    s_waitcnt lgkmcnt(0)
    v_mfma_f32_16x16x32_bf16 v[148:151], v[200:203], v[104:107], v[148:151]
    v_mfma_f32_16x16x32_bf16 v[156:159], v[200:203], v[120:123], v[156:159]
    v_mfma_f32_16x16x32_bf16 v[164:167], v[200:203], v[136:139], v[164:167]
    v_mfma_f32_16x16x32_bf16 v[148:151], v[204:207], v[108:111], v[148:151]
    v_mfma_f32_16x16x32_bf16 v[156:159], v[204:207], v[124:127], v[156:159]
    v_mfma_f32_16x16x32_bf16 v[164:167], v[204:207], v[140:143], v[164:167]
    v_subrev_u32_e32 v252, s39, v252
    s_waitcnt lgkmcnt(0)
    ds_inc_u32 v255, v236
    s_nop 3
    v_max3_f32 v198, v144, v145, v146
    v_max3_f32 v198, v198, v147, v148
    v_max3_f32 v198, v198, v149, v150
    v_max_f32_e32 v198, v198, v151
    v_mov_b32_e64 v199, v198
    v_mov_b32_e64 v200, v198
    s_nop 1
    v_permlane16_swap_b32 v199, v200
    s_nop 1
    v_max_f32_e32 v198, v199, v200
    v_mov_b32_e64 v199, v198
    v_mov_b32_e64 v200, v198
    s_nop 1
    v_permlane32_swap_b32 v199, v200
    s_nop 1
    v_max_f32_e32 v198, v199, v200
    v_sub_f32_e64 v240, 0, v198
    v_sub_f32_e64 v241, 0, v198
    v_sub_f32_e64 v242, 0, v198
    v_sub_f32_e64 v243, 0, v198
    v_sub_f32_e64 v144, v144, v198
    v_sub_f32_e64 v145, v145, v198
    v_sub_f32_e64 v146, v146, v198
    v_sub_f32_e64 v147, v147, v198
    v_sub_f32_e64 v148, v148, v198
    v_sub_f32_e64 v149, v149, v198
    v_sub_f32_e64 v150, v150, v198
    v_sub_f32_e64 v151, v151, v198
    v_max3_f32 v198, v152, v153, v154
    v_max3_f32 v198, v198, v155, v156
    v_max3_f32 v198, v198, v157, v158
    v_max_f32_e64 v198, v198, v159
    v_mov_b32_e64 v199, v198
    v_mov_b32_e64 v200, v198
    s_nop 1
    v_permlane16_swap_b32 v199, v200
    s_nop 1
    v_max_f32_e32 v198, v199, v200
    v_mov_b32_e64 v199, v198
    v_mov_b32_e64 v200, v198
    s_nop 1
    v_permlane32_swap_b32 v199, v200
    s_nop 1
    v_max_f32_e32 v198, v199, v200
    v_sub_f32_e64 v244, 0, v198
    v_sub_f32_e64 v245, 0, v198
    v_sub_f32_e64 v246, 0, v198
    v_sub_f32_e64 v247, 0, v198
    v_sub_f32_e64 v152, v152, v198
    v_sub_f32_e64 v153, v153, v198
    v_sub_f32_e64 v154, v154, v198
    v_sub_f32_e64 v155, v155, v198
    v_sub_f32_e64 v156, v156, v198
    v_sub_f32_e64 v157, v157, v198
    v_sub_f32_e64 v158, v158, v198
    v_sub_f32_e64 v159, v159, v198
    v_max3_f32 v198, v160, v161, v162
    v_max3_f32 v198, v198, v163, v164
    v_max3_f32 v198, v198, v165, v166
    v_max_f32_e64 v198, v198, v167
    v_mov_b32_e64 v199, v198
    v_mov_b32_e64 v200, v198
    s_nop 1
    v_permlane16_swap_b32 v199, v200
    s_nop 1
    v_max_f32_e32 v198, v199, v200
    v_mov_b32_e64 v199, v198
    v_mov_b32_e64 v200, v198
    s_nop 1
    v_permlane32_swap_b32 v199, v200
    s_nop 1
    v_max_f32_e32 v198, v199, v200
    v_sub_f32_e64 v248, 0, v198
    v_sub_f32_e64 v249, 0, v198
    v_sub_f32_e64 v250, 0, v198
    v_sub_f32_e64 v251, 0, v198
    v_sub_f32_e64 v160, v160, v198
    v_sub_f32_e64 v161, v161, v198
    v_sub_f32_e64 v162, v162, v198
    v_sub_f32_e64 v163, v163, v198
    v_sub_f32_e64 v164, v164, v198
    v_sub_f32_e64 v165, v165, v198
    v_sub_f32_e64 v166, v166, v198
    v_sub_f32_e64 v167, v167, v198
    v_exp_f32_e64 v144, v144
    v_exp_f32_e64 v145, v145
    v_exp_f32_e64 v146, v146
    v_exp_f32_e64 v147, v147
    v_exp_f32_e64 v148, v148
    v_exp_f32_e64 v149, v149
    v_exp_f32_e64 v150, v150
    v_exp_f32_e64 v151, v151
    v_exp_f32_e64 v152, v152
    v_exp_f32_e64 v153, v153
    v_exp_f32_e64 v154, v154
    v_exp_f32_e64 v155, v155
    ds_read_b32 v194, v254 offset:1024
    s_waitcnt lgkmcnt(0)
    v_cmp_gt_u32_e32 vcc, s47, v194
    s_cbranch_vccnz L_w1
L_w1_ret:
    s_mov_b32 s31, 8
    ds_read_b128 v[192:195], v252 offset:0
    ds_read_b128 v[196:199], v252 offset:64
    ds_read_b128 v[200:203], v252 offset:128
    ds_read_b128 v[204:207], v252 offset:192
L_loop:
    s_waitcnt lgkmcnt(2)
    v_mfma_f32_16x16x32_bf16 v[168:171], v[192:195], v[96:99], v[240:243]
    v_exp_f32_e32 v156, v156
    v_mfma_f32_16x16x32_bf16 v[176:179], v[192:195], v[112:115], v[244:247]
    ds_read_b64_tr_b16 v[208:209], v253 offset:8448
    v_cvt_pk_bf16_f32 v144, v144, v145
    v_mfma_f32_16x16x32_bf16 v[184:187], v[192:195], v[128:131], v[248:251]
    v_exp_f32_e64 v157, v157
    v_mfma_f32_16x16x32_bf16 v[168:171], v[196:199], v[100:103], v[168:171]
    ds_read_b128 v[192:195], v252 offset:512
    v_cvt_pk_bf16_f32 v145, v146, v147
    v_mfma_f32_16x16x32_bf16 v[176:179], v[196:199], v[116:119], v[176:179]
    v_exp_f32_e64 v158, v158
    v_mfma_f32_16x16x32_bf16 v[184:187], v[196:199], v[132:135], v[184:187]
    s_waitcnt lgkmcnt(2)
    ds_read_b128 v[196:199], v252 offset:576
    v_cvt_pk_bf16_f32 v146, v148, v149
    v_mfma_f32_16x16x32_bf16 v[168:171], v[200:203], v[104:107], v[168:171]
    v_exp_f32_e32 v159, v159
    v_mfma_f32_16x16x32_bf16 v[176:179], v[200:203], v[120:123], v[176:179]
    ds_read_b64_tr_b16 v[210:211], v253 offset:8960
    v_cvt_pk_bf16_f32 v147, v150, v151
    v_mfma_f32_16x16x32_bf16 v[184:187], v[200:203], v[136:139], v[184:187]
    v_exp_f32_e64 v160, v160
    v_mfma_f32_16x16x32_bf16 v[168:171], v[204:207], v[108:111], v[168:171]
    ds_read_b128 v[200:203], v252 offset:640
    v_cvt_pk_bf16_f32 v152, v152, v153
    v_mfma_f32_16x16x32_bf16 v[176:179], v[204:207], v[124:127], v[176:179]
    v_exp_f32_e64 v161, v161
    v_mfma_f32_16x16x32_bf16 v[184:187], v[204:207], v[140:143], v[184:187]
    s_waitcnt lgkmcnt(2)
    ds_read_b128 v[204:207], v252 offset:704
    v_cvt_pk_bf16_f32 v153, v154, v155
    v_mfma_f32_16x16x32_bf16 v[172:175], v[192:195], v[96:99], v[240:243]
    v_exp_f32_e32 v162, v162
    v_mfma_f32_16x16x32_bf16 v[180:183], v[192:195], v[112:115], v[244:247]
    ds_read_b64_tr_b16 v[212:213], v253 offset:8480
    v_cvt_pk_bf16_f32 v154, v156, v157
    v_mfma_f32_16x16x32_bf16 v[188:191], v[192:195], v[128:131], v[248:251]
    v_exp_f32_e64 v163, v163
    v_mfma_f32_16x16x32_bf16 v[172:175], v[196:199], v[100:103], v[172:175]
    ds_read_b64_tr_b16 v[214:215], v253 offset:8992
    v_cvt_pk_bf16_f32 v155, v158, v159
    v_mfma_f32_16x16x32_bf16 v[180:183], v[196:199], v[116:119], v[180:183]
    v_exp_f32_e64 v164, v164
    v_mfma_f32_16x16x32_bf16 v[188:191], v[196:199], v[132:135], v[188:191]
    s_waitcnt lgkmcnt(2)
    ds_read_b64_tr_b16 v[216:217], v253 offset:8512
    v_cvt_pk_bf16_f32 v160, v160, v161
    v_mfma_f32_16x16x32_bf16 v[172:175], v[200:203], v[104:107], v[172:175]
    v_exp_f32_e32 v165, v165
    v_mfma_f32_16x16x32_bf16 v[180:183], v[200:203], v[120:123], v[180:183]
    ds_read_b64_tr_b16 v[218:219], v253 offset:9024
    v_cvt_pk_bf16_f32 v161, v162, v163
    v_mfma_f32_16x16x32_bf16 v[188:191], v[200:203], v[136:139], v[188:191]
    v_exp_f32_e64 v166, v166
    v_mfma_f32_16x16x32_bf16 v[172:175], v[204:207], v[108:111], v[172:175]
    ds_read_b64_tr_b16 v[220:221], v253 offset:8544
    v_cvt_pk_bf16_f32 v162, v164, v165
    v_mfma_f32_16x16x32_bf16 v[180:183], v[204:207], v[124:127], v[180:183]
    v_exp_f32_e64 v167, v167
    v_mfma_f32_16x16x32_bf16 v[188:191], v[204:207], v[140:143], v[188:191]
    ds_read_b64_tr_b16 v[222:223], v253 offset:9056
    v_cvt_pk_bf16_f32 v163, v166, v167
    v_mfma_f32_16x16x32_bf16 v[224:227], v[236:239], v[144:147], v[224:227]
    ds_read_b32 v194, v254 offset:17920
    v_max3_f32 v192, v168, v169, v170
    v_mfma_f32_16x16x32_bf16 v[228:231], v[236:239], v[152:155], v[228:231]
    v_max3_f32 v192, v192, v171, v176
    v_max3_f32 v192, v192, v177, v178
    v_max3_f32 v192, v192, v179, v184
    v_mfma_f32_16x16x32_bf16 v[232:235], v[236:239], v[160:163], v[232:235]
    s_waitcnt lgkmcnt(5)
    v_max3_f32 v192, v192, v185, v186
    v_max3_f32 v192, v192, v187, v172
    v_mfma_f32_16x16x32_bf16 v[0:3], v[208:211], v[144:147], v[0:3]
    v_max3_f32 v192, v192, v173, v174
    v_max3_f32 v192, v192, v175, v180
    v_mfma_f32_16x16x32_bf16 v[32:35], v[208:211], v[152:155], v[32:35]
    v_max3_f32 v192, v192, v181, v182
    v_max3_f32 v192, v192, v183, v188
    v_mfma_f32_16x16x32_bf16 v[64:67], v[208:211], v[160:163], v[64:67]
    ds_read_b64_tr_b16 v[208:209], v253 offset:8576
    v_max3_f32 v192, v192, v189, v190
    v_mfma_f32_16x16x32_bf16 v[4:7], v[212:215], v[144:147], v[4:7]
    s_waitcnt lgkmcnt(1)
    ds_read_b64_tr_b16 v[210:211], v253 offset:9088
    v_max_f32_e64 v192, v192, v191
    v_mfma_f32_16x16x32_bf16 v[36:39], v[212:215], v[152:155], v[36:39]
    v_cmp_lt_f32_e64 vcc, s30, v192
    v_cmp_gt_u32 s[50:51], s47, v194
    v_mfma_f32_16x16x32_bf16 v[68:71], v[212:215], v[160:163], v[68:71]
    s_or_b64 vcc, vcc, s[50:51]
    s_cbranch_scc1 L_m0_slow
L_m0_slow_ret:
    ds_read_b64_tr_b16 v[212:213], v253 offset:8608
    v_exp_f32_e64 v168, v168
    v_mfma_f32_16x16x32_bf16 v[8:11], v[216:219], v[144:147], v[8:11]
    ds_read_b64_tr_b16 v[214:215], v253 offset:9120
    v_exp_f32_e64 v169, v169
    v_mfma_f32_16x16x32_bf16 v[40:43], v[216:219], v[152:155], v[40:43]
    v_exp_f32_e64 v170, v170
    v_mfma_f32_16x16x32_bf16 v[72:75], v[216:219], v[160:163], v[72:75]
    ds_read_b64_tr_b16 v[216:217], v253 offset:8640
    v_exp_f32_e64 v171, v171
    v_mfma_f32_16x16x32_bf16 v[12:15], v[220:223], v[144:147], v[12:15]
    ds_read_b64_tr_b16 v[218:219], v253 offset:9152
    v_exp_f32_e64 v172, v172
    v_mfma_f32_16x16x32_bf16 v[44:47], v[220:223], v[152:155], v[44:47]
    v_exp_f32_e64 v173, v173
    v_mfma_f32_16x16x32_bf16 v[76:79], v[220:223], v[160:163], v[76:79]
    s_waitcnt lgkmcnt(2)
    ds_read_b64_tr_b16 v[220:221], v253 offset:8672
    v_mfma_f32_16x16x32_bf16 v[16:19], v[208:211], v[144:147], v[16:19]
    ds_read_b64_tr_b16 v[222:223], v253 offset:9184
    v_mfma_f32_16x16x32_bf16 v[48:51], v[208:211], v[152:155], v[48:51]
    v_exp_f32_e32 v174, v174
    v_mfma_f32_16x16x32_bf16 v[80:83], v[208:211], v[160:163], v[80:83]
    v_exp_f32_e64 v175, v175
    v_mfma_f32_16x16x32_bf16 v[20:23], v[212:215], v[144:147], v[20:23]
    v_exp_f32_e64 v176, v176
    v_mfma_f32_16x16x32_bf16 v[52:55], v[212:215], v[152:155], v[52:55]
    v_exp_f32_e64 v177, v177
    v_mfma_f32_16x16x32_bf16 v[84:87], v[212:215], v[160:163], v[84:87]
    s_waitcnt lgkmcnt(0)
    ds_inc_u32 v255, v236
    v_mfma_f32_16x16x32_bf16 v[24:27], v[216:219], v[144:147], v[24:27]
    v_exp_f32_e32 v178, v178
    v_mfma_f32_16x16x32_bf16 v[56:59], v[216:219], v[152:155], v[56:59]
    v_exp_f32_e64 v179, v179
    v_mfma_f32_16x16x32_bf16 v[88:91], v[216:219], v[160:163], v[88:91]
    ds_read_b128 v[192:195], v252 offset:16896
    v_mfma_f32_16x16x32_bf16 v[28:31], v[220:223], v[144:147], v[28:31]
    ds_read_b128 v[196:199], v252 offset:16960
    v_mfma_f32_16x16x32_bf16 v[60:63], v[220:223], v[152:155], v[60:63]
    ds_read_b128 v[200:203], v252 offset:17024
    v_mfma_f32_16x16x32_bf16 v[92:95], v[220:223], v[160:163], v[92:95]
    ds_read_b128 v[204:207], v252 offset:17088
L_m0_end:
    s_waitcnt lgkmcnt(2)
    v_mfma_f32_16x16x32_bf16 v[144:147], v[192:195], v[96:99], v[240:243]
    v_exp_f32_e32 v180, v180
    v_mfma_f32_16x16x32_bf16 v[152:155], v[192:195], v[112:115], v[244:247]
    ds_read_b64_tr_b16 v[208:209], v253 offset:25344
    v_cvt_pk_bf16_f32 v168, v168, v169
    v_mfma_f32_16x16x32_bf16 v[160:163], v[192:195], v[128:131], v[248:251]
    v_exp_f32_e64 v181, v181
    v_mfma_f32_16x16x32_bf16 v[144:147], v[196:199], v[100:103], v[144:147]
    ds_read_b128 v[192:195], v252 offset:17408
    v_cvt_pk_bf16_f32 v169, v170, v171
    v_mfma_f32_16x16x32_bf16 v[152:155], v[196:199], v[116:119], v[152:155]
    v_exp_f32_e64 v182, v182
    v_mfma_f32_16x16x32_bf16 v[160:163], v[196:199], v[132:135], v[160:163]
    s_waitcnt lgkmcnt(2)
    ds_read_b128 v[196:199], v252 offset:17472
    v_cvt_pk_bf16_f32 v170, v172, v173
    v_mfma_f32_16x16x32_bf16 v[144:147], v[200:203], v[104:107], v[144:147]
    v_exp_f32_e32 v183, v183
    v_mfma_f32_16x16x32_bf16 v[152:155], v[200:203], v[120:123], v[152:155]
    ds_read_b64_tr_b16 v[210:211], v253 offset:25856
    v_cvt_pk_bf16_f32 v171, v174, v175
    v_mfma_f32_16x16x32_bf16 v[160:163], v[200:203], v[136:139], v[160:163]
    v_exp_f32_e64 v184, v184
    v_mfma_f32_16x16x32_bf16 v[144:147], v[204:207], v[108:111], v[144:147]
    ds_read_b128 v[200:203], v252 offset:17536
    v_cvt_pk_bf16_f32 v176, v176, v177
    v_mfma_f32_16x16x32_bf16 v[152:155], v[204:207], v[124:127], v[152:155]
    v_exp_f32_e64 v185, v185
    v_mfma_f32_16x16x32_bf16 v[160:163], v[204:207], v[140:143], v[160:163]
    s_waitcnt lgkmcnt(2)
    ds_read_b128 v[204:207], v252 offset:17600
    v_cvt_pk_bf16_f32 v177, v178, v179
    v_mfma_f32_16x16x32_bf16 v[148:151], v[192:195], v[96:99], v[240:243]
    v_exp_f32_e32 v186, v186
    v_mfma_f32_16x16x32_bf16 v[156:159], v[192:195], v[112:115], v[244:247]
    ds_read_b64_tr_b16 v[212:213], v253 offset:25376
    v_cvt_pk_bf16_f32 v178, v180, v181
    v_mfma_f32_16x16x32_bf16 v[164:167], v[192:195], v[128:131], v[248:251]
    v_exp_f32_e64 v187, v187
    v_mfma_f32_16x16x32_bf16 v[148:151], v[196:199], v[100:103], v[148:151]
    ds_read_b64_tr_b16 v[214:215], v253 offset:25888
    v_cvt_pk_bf16_f32 v179, v182, v183
    v_mfma_f32_16x16x32_bf16 v[156:159], v[196:199], v[116:119], v[156:159]
    v_exp_f32_e64 v188, v188
    v_mfma_f32_16x16x32_bf16 v[164:167], v[196:199], v[132:135], v[164:167]
    s_waitcnt lgkmcnt(2)
    ds_read_b64_tr_b16 v[216:217], v253 offset:25408
    v_cvt_pk_bf16_f32 v184, v184, v185
    v_mfma_f32_16x16x32_bf16 v[148:151], v[200:203], v[104:107], v[148:151]
    v_exp_f32_e32 v189, v189
    v_mfma_f32_16x16x32_bf16 v[156:159], v[200:203], v[120:123], v[156:159]
    ds_read_b64_tr_b16 v[218:219], v253 offset:25920
    v_cvt_pk_bf16_f32 v185, v186, v187
    v_mfma_f32_16x16x32_bf16 v[164:167], v[200:203], v[136:139], v[164:167]
    v_exp_f32_e64 v190, v190
    v_mfma_f32_16x16x32_bf16 v[148:151], v[204:207], v[108:111], v[148:151]
    ds_read_b64_tr_b16 v[220:221], v253 offset:25440
    v_cvt_pk_bf16_f32 v186, v188, v189
    v_mfma_f32_16x16x32_bf16 v[156:159], v[204:207], v[124:127], v[156:159]
    v_exp_f32_e64 v191, v191
    v_mfma_f32_16x16x32_bf16 v[164:167], v[204:207], v[140:143], v[164:167]
    ds_read_b64_tr_b16 v[222:223], v253 offset:25952
    v_cvt_pk_bf16_f32 v187, v190, v191
    v_mfma_f32_16x16x32_bf16 v[224:227], v[236:239], v[168:171], v[224:227]
    ds_read_b32 v194, v254 offset:34816
    v_max3_f32 v192, v144, v145, v146
    v_mfma_f32_16x16x32_bf16 v[228:231], v[236:239], v[176:179], v[228:231]
    v_max3_f32 v192, v192, v147, v152
    v_max3_f32 v192, v192, v153, v154
    v_max3_f32 v192, v192, v155, v160
    v_mfma_f32_16x16x32_bf16 v[232:235], v[236:239], v[184:187], v[232:235]
    s_waitcnt lgkmcnt(5)
    v_max3_f32 v192, v192, v161, v162
    v_max3_f32 v192, v192, v163, v148
    v_mfma_f32_16x16x32_bf16 v[0:3], v[208:211], v[168:171], v[0:3]
    v_max3_f32 v192, v192, v149, v150
    v_max3_f32 v192, v192, v151, v156
    v_mfma_f32_16x16x32_bf16 v[32:35], v[208:211], v[176:179], v[32:35]
    v_max3_f32 v192, v192, v157, v158
    v_max3_f32 v192, v192, v159, v164
    v_mfma_f32_16x16x32_bf16 v[64:67], v[208:211], v[184:187], v[64:67]
    ds_read_b64_tr_b16 v[208:209], v253 offset:25472
    v_max3_f32 v192, v192, v165, v166
    v_mfma_f32_16x16x32_bf16 v[4:7], v[212:215], v[168:171], v[4:7]
    s_waitcnt lgkmcnt(1)
    ds_read_b64_tr_b16 v[210:211], v253 offset:25984
    v_max_f32_e64 v192, v192, v167
    v_mfma_f32_16x16x32_bf16 v[36:39], v[212:215], v[176:179], v[36:39]
    v_cmp_lt_f32_e64 vcc, s30, v192
    v_cmp_gt_u32 s[50:51], s47, v194
    v_mfma_f32_16x16x32_bf16 v[68:71], v[212:215], v[184:187], v[68:71]
    s_or_b64 vcc, vcc, s[50:51]
    s_cbranch_scc1 L_m1_slow
L_m1_slow_ret:
    ds_read_b64_tr_b16 v[212:213], v253 offset:25504
    v_exp_f32_e64 v144, v144
    v_mfma_f32_16x16x32_bf16 v[8:11], v[216:219], v[168:171], v[8:11]
    ds_read_b64_tr_b16 v[214:215], v253 offset:26016
    v_exp_f32_e64 v145, v145
    v_mfma_f32_16x16x32_bf16 v[40:43], v[216:219], v[176:179], v[40:43]
    v_exp_f32_e64 v146, v146
    v_mfma_f32_16x16x32_bf16 v[72:75], v[216:219], v[184:187], v[72:75]
    ds_read_b64_tr_b16 v[216:217], v253 offset:25536
    v_exp_f32_e64 v147, v147
    v_mfma_f32_16x16x32_bf16 v[12:15], v[220:223], v[168:171], v[12:15]
    ds_read_b64_tr_b16 v[218:219], v253 offset:26048
    v_exp_f32_e64 v148, v148
    v_mfma_f32_16x16x32_bf16 v[44:47], v[220:223], v[176:179], v[44:47]
    v_exp_f32_e64 v149, v149
    v_mfma_f32_16x16x32_bf16 v[76:79], v[220:223], v[184:187], v[76:79]
    s_waitcnt lgkmcnt(2)
    ds_read_b64_tr_b16 v[220:221], v253 offset:25568
    v_mfma_f32_16x16x32_bf16 v[16:19], v[208:211], v[168:171], v[16:19]
    ds_read_b64_tr_b16 v[222:223], v253 offset:26080
    v_mfma_f32_16x16x32_bf16 v[48:51], v[208:211], v[176:179], v[48:51]
    v_exp_f32_e32 v150, v150
    v_mfma_f32_16x16x32_bf16 v[80:83], v[208:211], v[184:187], v[80:83]
    v_exp_f32_e64 v151, v151
    v_mfma_f32_16x16x32_bf16 v[20:23], v[212:215], v[168:171], v[20:23]
    v_exp_f32_e64 v152, v152
    v_mfma_f32_16x16x32_bf16 v[52:55], v[212:215], v[176:179], v[52:55]
    v_exp_f32_e64 v153, v153
    v_mfma_f32_16x16x32_bf16 v[84:87], v[212:215], v[184:187], v[84:87]
    s_waitcnt lgkmcnt(0)
    ds_inc_u32 v255, v236
    v_mfma_f32_16x16x32_bf16 v[24:27], v[216:219], v[168:171], v[24:27]
    v_exp_f32_e32 v154, v154
    v_mfma_f32_16x16x32_bf16 v[56:59], v[216:219], v[176:179], v[56:59]
    v_exp_f32_e64 v155, v155
    v_mfma_f32_16x16x32_bf16 v[88:91], v[216:219], v[184:187], v[88:91]
    ds_read_b128 v[192:195], v252 offset:33792
    v_mfma_f32_16x16x32_bf16 v[28:31], v[220:223], v[168:171], v[28:31]
    ds_read_b128 v[196:199], v252 offset:33856
    v_mfma_f32_16x16x32_bf16 v[60:63], v[220:223], v[176:179], v[60:63]
    ds_read_b128 v[200:203], v252 offset:33920
    v_mfma_f32_16x16x32_bf16 v[92:95], v[220:223], v[184:187], v[92:95]
    ds_read_b128 v[204:207], v252 offset:33984
L_m1_end:
    s_waitcnt lgkmcnt(2)
    v_mfma_f32_16x16x32_bf16 v[168:171], v[192:195], v[96:99], v[240:243]
    v_exp_f32_e32 v156, v156
    v_mfma_f32_16x16x32_bf16 v[176:179], v[192:195], v[112:115], v[244:247]
    ds_read_b64_tr_b16 v[208:209], v253 offset:42240
    v_cvt_pk_bf16_f32 v144, v144, v145
    v_mfma_f32_16x16x32_bf16 v[184:187], v[192:195], v[128:131], v[248:251]
    v_exp_f32_e64 v157, v157
    v_mfma_f32_16x16x32_bf16 v[168:171], v[196:199], v[100:103], v[168:171]
    ds_read_b128 v[192:195], v252 offset:34304
    v_cvt_pk_bf16_f32 v145, v146, v147
    v_mfma_f32_16x16x32_bf16 v[176:179], v[196:199], v[116:119], v[176:179]
    v_exp_f32_e64 v158, v158
    v_mfma_f32_16x16x32_bf16 v[184:187], v[196:199], v[132:135], v[184:187]
    s_waitcnt lgkmcnt(2)
    ds_read_b128 v[196:199], v252 offset:34368
    v_cvt_pk_bf16_f32 v146, v148, v149
    v_mfma_f32_16x16x32_bf16 v[168:171], v[200:203], v[104:107], v[168:171]
    v_exp_f32_e32 v159, v159
    v_mfma_f32_16x16x32_bf16 v[176:179], v[200:203], v[120:123], v[176:179]
    ds_read_b64_tr_b16 v[210:211], v253 offset:42752
    v_cvt_pk_bf16_f32 v147, v150, v151
    v_mfma_f32_16x16x32_bf16 v[184:187], v[200:203], v[136:139], v[184:187]
    v_exp_f32_e64 v160, v160
    v_mfma_f32_16x16x32_bf16 v[168:171], v[204:207], v[108:111], v[168:171]
    ds_read_b128 v[200:203], v252 offset:34432
    v_cvt_pk_bf16_f32 v152, v152, v153
    v_mfma_f32_16x16x32_bf16 v[176:179], v[204:207], v[124:127], v[176:179]
    v_exp_f32_e64 v161, v161
    v_mfma_f32_16x16x32_bf16 v[184:187], v[204:207], v[140:143], v[184:187]
    s_waitcnt lgkmcnt(2)
    ds_read_b128 v[204:207], v252 offset:34496
    v_cvt_pk_bf16_f32 v153, v154, v155
    v_mfma_f32_16x16x32_bf16 v[172:175], v[192:195], v[96:99], v[240:243]
    v_exp_f32_e32 v162, v162
    v_mfma_f32_16x16x32_bf16 v[180:183], v[192:195], v[112:115], v[244:247]
    ds_read_b64_tr_b16 v[212:213], v253 offset:42272
    v_cvt_pk_bf16_f32 v154, v156, v157
    v_mfma_f32_16x16x32_bf16 v[188:191], v[192:195], v[128:131], v[248:251]
    v_exp_f32_e64 v163, v163
    v_mfma_f32_16x16x32_bf16 v[172:175], v[196:199], v[100:103], v[172:175]
    ds_read_b64_tr_b16 v[214:215], v253 offset:42784
    v_cvt_pk_bf16_f32 v155, v158, v159
    v_mfma_f32_16x16x32_bf16 v[180:183], v[196:199], v[116:119], v[180:183]
    v_exp_f32_e64 v164, v164
    v_mfma_f32_16x16x32_bf16 v[188:191], v[196:199], v[132:135], v[188:191]
    s_waitcnt lgkmcnt(2)
    ds_read_b64_tr_b16 v[216:217], v253 offset:42304
    v_cvt_pk_bf16_f32 v160, v160, v161
    v_mfma_f32_16x16x32_bf16 v[172:175], v[200:203], v[104:107], v[172:175]
    v_exp_f32_e32 v165, v165
    v_mfma_f32_16x16x32_bf16 v[180:183], v[200:203], v[120:123], v[180:183]
    ds_read_b64_tr_b16 v[218:219], v253 offset:42816
    v_cvt_pk_bf16_f32 v161, v162, v163
    v_mfma_f32_16x16x32_bf16 v[188:191], v[200:203], v[136:139], v[188:191]
    v_exp_f32_e64 v166, v166
    v_mfma_f32_16x16x32_bf16 v[172:175], v[204:207], v[108:111], v[172:175]
    ds_read_b64_tr_b16 v[220:221], v253 offset:42336
    v_cvt_pk_bf16_f32 v162, v164, v165
    v_mfma_f32_16x16x32_bf16 v[180:183], v[204:207], v[124:127], v[180:183]
    v_exp_f32_e64 v167, v167
    v_mfma_f32_16x16x32_bf16 v[188:191], v[204:207], v[140:143], v[188:191]
    ds_read_b64_tr_b16 v[222:223], v253 offset:42848
    v_cvt_pk_bf16_f32 v163, v166, v167
    v_mfma_f32_16x16x32_bf16 v[224:227], v[236:239], v[144:147], v[224:227]
    ds_read_b32 v194, v254 offset:51712
    v_max3_f32 v192, v168, v169, v170
    v_mfma_f32_16x16x32_bf16 v[228:231], v[236:239], v[152:155], v[228:231]
    v_max3_f32 v192, v192, v171, v176
    v_max3_f32 v192, v192, v177, v178
    v_max3_f32 v192, v192, v179, v184
    v_mfma_f32_16x16x32_bf16 v[232:235], v[236:239], v[160:163], v[232:235]
    s_waitcnt lgkmcnt(5)
    v_max3_f32 v192, v192, v185, v186
    v_max3_f32 v192, v192, v187, v172
    v_mfma_f32_16x16x32_bf16 v[0:3], v[208:211], v[144:147], v[0:3]
    v_max3_f32 v192, v192, v173, v174
    v_max3_f32 v192, v192, v175, v180
    v_mfma_f32_16x16x32_bf16 v[32:35], v[208:211], v[152:155], v[32:35]
    v_max3_f32 v192, v192, v181, v182
    v_max3_f32 v192, v192, v183, v188
    v_mfma_f32_16x16x32_bf16 v[64:67], v[208:211], v[160:163], v[64:67]
    ds_read_b64_tr_b16 v[208:209], v253 offset:42368
    v_max3_f32 v192, v192, v189, v190
    v_mfma_f32_16x16x32_bf16 v[4:7], v[212:215], v[144:147], v[4:7]
    s_waitcnt lgkmcnt(1)
    ds_read_b64_tr_b16 v[210:211], v253 offset:42880
    v_max_f32_e64 v192, v192, v191
    v_mfma_f32_16x16x32_bf16 v[36:39], v[212:215], v[152:155], v[36:39]
    v_cmp_lt_f32_e64 vcc, s30, v192
    v_cmp_gt_u32 s[50:51], s47, v194
    v_mfma_f32_16x16x32_bf16 v[68:71], v[212:215], v[160:163], v[68:71]
    s_or_b64 vcc, vcc, s[50:51]
    s_cbranch_scc1 L_m2_slow
L_m2_slow_ret:
    ds_read_b64_tr_b16 v[212:213], v253 offset:42400
    v_exp_f32_e64 v168, v168
    v_mfma_f32_16x16x32_bf16 v[8:11], v[216:219], v[144:147], v[8:11]
    ds_read_b64_tr_b16 v[214:215], v253 offset:42912
    v_exp_f32_e64 v169, v169
    v_mfma_f32_16x16x32_bf16 v[40:43], v[216:219], v[152:155], v[40:43]
    v_exp_f32_e64 v170, v170
    v_mfma_f32_16x16x32_bf16 v[72:75], v[216:219], v[160:163], v[72:75]
    ds_read_b64_tr_b16 v[216:217], v253 offset:42432
    v_exp_f32_e64 v171, v171
    v_mfma_f32_16x16x32_bf16 v[12:15], v[220:223], v[144:147], v[12:15]
    ds_read_b64_tr_b16 v[218:219], v253 offset:42944
    v_exp_f32_e64 v172, v172
    v_mfma_f32_16x16x32_bf16 v[44:47], v[220:223], v[152:155], v[44:47]
    v_exp_f32_e64 v173, v173
    v_mfma_f32_16x16x32_bf16 v[76:79], v[220:223], v[160:163], v[76:79]
    s_waitcnt lgkmcnt(2)
    ds_read_b64_tr_b16 v[220:221], v253 offset:42464
    v_mfma_f32_16x16x32_bf16 v[16:19], v[208:211], v[144:147], v[16:19]
    ds_read_b64_tr_b16 v[222:223], v253 offset:42976
    v_mfma_f32_16x16x32_bf16 v[48:51], v[208:211], v[152:155], v[48:51]
    v_exp_f32_e32 v174, v174
    v_mfma_f32_16x16x32_bf16 v[80:83], v[208:211], v[160:163], v[80:83]
    v_exp_f32_e64 v175, v175
    v_mfma_f32_16x16x32_bf16 v[20:23], v[212:215], v[144:147], v[20:23]
    v_exp_f32_e64 v176, v176
    v_mfma_f32_16x16x32_bf16 v[52:55], v[212:215], v[152:155], v[52:55]
    v_exp_f32_e64 v177, v177
    v_mfma_f32_16x16x32_bf16 v[84:87], v[212:215], v[160:163], v[84:87]
    s_waitcnt lgkmcnt(0)
    ds_inc_u32 v255, v236
    v_mfma_f32_16x16x32_bf16 v[24:27], v[216:219], v[144:147], v[24:27]
    v_exp_f32_e32 v178, v178
    v_mfma_f32_16x16x32_bf16 v[56:59], v[216:219], v[152:155], v[56:59]
    v_exp_f32_e64 v179, v179
    v_mfma_f32_16x16x32_bf16 v[88:91], v[216:219], v[160:163], v[88:91]
    ds_read_b128 v[192:195], v252 offset:50688
    v_mfma_f32_16x16x32_bf16 v[28:31], v[220:223], v[144:147], v[28:31]
    ds_read_b128 v[196:199], v252 offset:50752
    v_mfma_f32_16x16x32_bf16 v[60:63], v[220:223], v[152:155], v[60:63]
    ds_read_b128 v[200:203], v252 offset:50816
    v_mfma_f32_16x16x32_bf16 v[92:95], v[220:223], v[160:163], v[92:95]
    ds_read_b128 v[204:207], v252 offset:50880
L_m2_end:
    s_sub_u32 s31, s31, 1
    s_cmp_eq_u32 s31, 0
    s_cbranch_scc1 L_final
    v_add_u32_e32 v254, s39, v254
    s_add_u32 s3, s3, 2
    s_and_b32 s47, s3, 0xfc
    s_waitcnt lgkmcnt(2)
    v_mfma_f32_16x16x32_bf16 v[144:147], v[192:195], v[96:99], v[240:243]
    v_exp_f32_e64 v180, v180
    v_mfma_f32_16x16x32_bf16 v[152:155], v[192:195], v[112:115], v[244:247]
    ds_read_b64_tr_b16 v[208:209], v253 offset:59136
    v_cvt_pk_bf16_f32 v168, v168, v169
    v_mfma_f32_16x16x32_bf16 v[160:163], v[192:195], v[128:131], v[248:251]
    v_exp_f32_e64 v181, v181
    v_mfma_f32_16x16x32_bf16 v[144:147], v[196:199], v[100:103], v[144:147]
    ds_read_b128 v[192:195], v252 offset:51200
    v_cvt_pk_bf16_f32 v169, v170, v171
    v_mfma_f32_16x16x32_bf16 v[152:155], v[196:199], v[116:119], v[152:155]
    v_exp_f32_e64 v182, v182
    v_mfma_f32_16x16x32_bf16 v[160:163], v[196:199], v[132:135], v[160:163]
    s_waitcnt lgkmcnt(2)
    ds_read_b128 v[196:199], v252 offset:51264
    v_cvt_pk_bf16_f32 v170, v172, v173
    v_mfma_f32_16x16x32_bf16 v[144:147], v[200:203], v[104:107], v[144:147]
    v_exp_f32_e32 v183, v183
    v_mfma_f32_16x16x32_bf16 v[152:155], v[200:203], v[120:123], v[152:155]
    ds_read_b64_tr_b16 v[210:211], v253 offset:59648
    v_cvt_pk_bf16_f32 v171, v174, v175
    v_mfma_f32_16x16x32_bf16 v[160:163], v[200:203], v[136:139], v[160:163]
    v_exp_f32_e64 v184, v184
    v_mfma_f32_16x16x32_bf16 v[144:147], v[204:207], v[108:111], v[144:147]
    ds_read_b128 v[200:203], v252 offset:51328
    v_cvt_pk_bf16_f32 v176, v176, v177
    v_mfma_f32_16x16x32_bf16 v[152:155], v[204:207], v[124:127], v[152:155]
    v_exp_f32_e64 v185, v185
    v_mfma_f32_16x16x32_bf16 v[160:163], v[204:207], v[140:143], v[160:163]
    s_waitcnt lgkmcnt(2)
    ds_read_b128 v[204:207], v252 offset:51392
    v_cvt_pk_bf16_f32 v177, v178, v179
    v_mfma_f32_16x16x32_bf16 v[148:151], v[192:195], v[96:99], v[240:243]
    v_exp_f32_e32 v186, v186
    v_mfma_f32_16x16x32_bf16 v[156:159], v[192:195], v[112:115], v[244:247]
    ds_read_b64_tr_b16 v[212:213], v253 offset:59168
    v_cvt_pk_bf16_f32 v178, v180, v181
    v_mfma_f32_16x16x32_bf16 v[164:167], v[192:195], v[128:131], v[248:251]
    v_exp_f32_e64 v187, v187
    v_mfma_f32_16x16x32_bf16 v[148:151], v[196:199], v[100:103], v[148:151]
    ds_read_b64_tr_b16 v[214:215], v253 offset:59680
    v_cvt_pk_bf16_f32 v179, v182, v183
    v_mfma_f32_16x16x32_bf16 v[156:159], v[196:199], v[116:119], v[156:159]
    v_exp_f32_e64 v188, v188
    v_mfma_f32_16x16x32_bf16 v[164:167], v[196:199], v[132:135], v[164:167]
    s_waitcnt lgkmcnt(2)
    ds_read_b64_tr_b16 v[216:217], v253 offset:59200
    v_cvt_pk_bf16_f32 v184, v184, v185
    v_mfma_f32_16x16x32_bf16 v[148:151], v[200:203], v[104:107], v[148:151]
    v_exp_f32_e32 v189, v189
    v_mfma_f32_16x16x32_bf16 v[156:159], v[200:203], v[120:123], v[156:159]
    ds_read_b64_tr_b16 v[218:219], v253 offset:59712
    v_cvt_pk_bf16_f32 v185, v186, v187
    v_mfma_f32_16x16x32_bf16 v[164:167], v[200:203], v[136:139], v[164:167]
    v_exp_f32_e64 v190, v190
    v_mfma_f32_16x16x32_bf16 v[148:151], v[204:207], v[108:111], v[148:151]
    ds_read_b64_tr_b16 v[220:221], v253 offset:59232
    v_cvt_pk_bf16_f32 v186, v188, v189
    v_mfma_f32_16x16x32_bf16 v[156:159], v[204:207], v[124:127], v[156:159]
    v_exp_f32_e64 v191, v191
    v_mfma_f32_16x16x32_bf16 v[164:167], v[204:207], v[140:143], v[164:167]
    ds_read_b64_tr_b16 v[222:223], v253 offset:59744
    v_cvt_pk_bf16_f32 v187, v190, v191
    v_mfma_f32_16x16x32_bf16 v[224:227], v[236:239], v[168:171], v[224:227]
    ds_read_b32 v194, v254 offset:1024
    v_max3_f32 v192, v144, v145, v146
    v_mfma_f32_16x16x32_bf16 v[228:231], v[236:239], v[176:179], v[228:231]
    v_max3_f32 v192, v192, v147, v152
    v_max3_f32 v192, v192, v153, v154
    v_max3_f32 v192, v192, v155, v160
    v_mfma_f32_16x16x32_bf16 v[232:235], v[236:239], v[184:187], v[232:235]
    s_waitcnt lgkmcnt(5)
    v_max3_f32 v192, v192, v161, v162
    v_max3_f32 v192, v192, v163, v148
    v_mfma_f32_16x16x32_bf16 v[0:3], v[208:211], v[168:171], v[0:3]
    v_max3_f32 v192, v192, v149, v150
    v_max3_f32 v192, v192, v151, v156
    v_mfma_f32_16x16x32_bf16 v[32:35], v[208:211], v[176:179], v[32:35]
    v_max3_f32 v192, v192, v157, v158
    v_max3_f32 v192, v192, v159, v164
    v_mfma_f32_16x16x32_bf16 v[64:67], v[208:211], v[184:187], v[64:67]
    ds_read_b64_tr_b16 v[208:209], v253 offset:59264
    v_max3_f32 v192, v192, v165, v166
    v_mfma_f32_16x16x32_bf16 v[4:7], v[212:215], v[168:171], v[4:7]
    s_waitcnt lgkmcnt(1)
    ds_read_b64_tr_b16 v[210:211], v253 offset:59776
    v_max_f32_e64 v192, v192, v167
    v_mfma_f32_16x16x32_bf16 v[36:39], v[212:215], v[176:179], v[36:39]
    v_cmp_lt_f32_e64 vcc, s30, v192
    v_cmp_gt_u32 s[50:51], s47, v194
    v_mfma_f32_16x16x32_bf16 v[68:71], v[212:215], v[184:187], v[68:71]
    s_or_b64 vcc, vcc, s[50:51]
    s_cbranch_scc1 L_m3_slow
L_m3_slow_ret:
    ds_read_b64_tr_b16 v[212:213], v253 offset:59296
    v_exp_f32_e64 v144, v144
    v_mfma_f32_16x16x32_bf16 v[8:11], v[216:219], v[168:171], v[8:11]
    ds_read_b64_tr_b16 v[214:215], v253 offset:59808
    v_exp_f32_e64 v145, v145
    v_mfma_f32_16x16x32_bf16 v[40:43], v[216:219], v[176:179], v[40:43]
    v_exp_f32_e64 v146, v146
    v_mfma_f32_16x16x32_bf16 v[72:75], v[216:219], v[184:187], v[72:75]
    ds_read_b64_tr_b16 v[216:217], v253 offset:59328
    v_exp_f32_e64 v147, v147
    v_mfma_f32_16x16x32_bf16 v[12:15], v[220:223], v[168:171], v[12:15]
    ds_read_b64_tr_b16 v[218:219], v253 offset:59840
    v_exp_f32_e64 v148, v148
    v_mfma_f32_16x16x32_bf16 v[44:47], v[220:223], v[176:179], v[44:47]
    v_exp_f32_e64 v149, v149
    v_mfma_f32_16x16x32_bf16 v[76:79], v[220:223], v[184:187], v[76:79]
    s_waitcnt lgkmcnt(2)
    ds_read_b64_tr_b16 v[220:221], v253 offset:59360
    v_mfma_f32_16x16x32_bf16 v[16:19], v[208:211], v[168:171], v[16:19]
    ds_read_b64_tr_b16 v[222:223], v253 offset:59872
    v_mfma_f32_16x16x32_bf16 v[48:51], v[208:211], v[176:179], v[48:51]
    v_exp_f32_e32 v150, v150
    v_mfma_f32_16x16x32_bf16 v[80:83], v[208:211], v[184:187], v[80:83]
    v_exp_f32_e64 v151, v151
    v_mfma_f32_16x16x32_bf16 v[20:23], v[212:215], v[168:171], v[20:23]
    v_exp_f32_e64 v152, v152
    v_mfma_f32_16x16x32_bf16 v[52:55], v[212:215], v[176:179], v[52:55]
    v_exp_f32_e64 v153, v153
    v_mfma_f32_16x16x32_bf16 v[84:87], v[212:215], v[184:187], v[84:87]
    s_waitcnt lgkmcnt(0)
    ds_inc_u32 v255, v236
    v_add_u32_e32 v252, s39, v252
    v_mfma_f32_16x16x32_bf16 v[24:27], v[216:219], v[168:171], v[24:27]
    v_exp_f32_e64 v154, v154
    v_mfma_f32_16x16x32_bf16 v[56:59], v[216:219], v[176:179], v[56:59]
    v_exp_f32_e64 v155, v155
    v_mfma_f32_16x16x32_bf16 v[88:91], v[216:219], v[184:187], v[88:91]
    ds_read_b128 v[192:195], v252 offset:0
    v_add_u32_e64 v253, s39, v253
    v_mfma_f32_16x16x32_bf16 v[28:31], v[220:223], v[168:171], v[28:31]
    ds_read_b128 v[196:199], v252 offset:64
    v_mfma_f32_16x16x32_bf16 v[60:63], v[220:223], v[176:179], v[60:63]
    s_sub_u32 s39, 0, s39
    ds_read_b128 v[200:203], v252 offset:128
    v_mfma_f32_16x16x32_bf16 v[92:95], v[220:223], v[184:187], v[92:95]
    ds_read_b128 v[204:207], v252 offset:192
L_m3_end:
    s_branch L_loop
L_final:
    ds_read_b64_tr_b16 v[208:209], v253 offset:59136
    ds_read_b64_tr_b16 v[210:211], v253 offset:59648
    ds_read_b64_tr_b16 v[212:213], v253 offset:59168
    ds_read_b64_tr_b16 v[214:215], v253 offset:59680
    ds_read_b64_tr_b16 v[216:217], v253 offset:59200
    ds_read_b64_tr_b16 v[218:219], v253 offset:59712
    ds_read_b64_tr_b16 v[220:221], v253 offset:59232
    ds_read_b64_tr_b16 v[222:223], v253 offset:59744
    v_exp_f32_e64 v180, v180
    v_exp_f32_e64 v181, v181
    v_exp_f32_e64 v182, v182
    v_exp_f32_e64 v183, v183
    v_cvt_pk_bf16_f32 v168, v168, v169
    v_cvt_pk_bf16_f32 v169, v170, v171
    v_cvt_pk_bf16_f32 v170, v172, v173
    v_cvt_pk_bf16_f32 v171, v174, v175
    v_exp_f32_e64 v184, v184
    v_exp_f32_e64 v185, v185
    v_exp_f32_e64 v186, v186
    v_exp_f32_e64 v187, v187
    v_exp_f32_e64 v188, v188
    v_exp_f32_e64 v189, v189
    v_exp_f32_e64 v190, v190
    v_exp_f32_e64 v191, v191
    v_cvt_pk_bf16_f32 v176, v176, v177
    v_cvt_pk_bf16_f32 v177, v178, v179
    v_cvt_pk_bf16_f32 v178, v180, v181
    v_cvt_pk_bf16_f32 v179, v182, v183
    v_cvt_pk_bf16_f32 v184, v184, v185
    v_cvt_pk_bf16_f32 v185, v186, v187
    v_cvt_pk_bf16_f32 v186, v188, v189
    v_cvt_pk_bf16_f32 v187, v190, v191
    s_nop 0
    v_mfma_f32_16x16x32_bf16 v[224:227], v[236:239], v[168:171], v[224:227]
    v_mfma_f32_16x16x32_bf16 v[228:231], v[236:239], v[176:179], v[228:231]
    v_mfma_f32_16x16x32_bf16 v[232:235], v[236:239], v[184:187], v[232:235]
    ds_read_b64_tr_b16 v[192:193], v253 offset:59264
    ds_read_b64_tr_b16 v[194:195], v253 offset:59776
    ds_read_b64_tr_b16 v[196:197], v253 offset:59296
    ds_read_b64_tr_b16 v[198:199], v253 offset:59808
    ds_read_b64_tr_b16 v[200:201], v253 offset:59328
    ds_read_b64_tr_b16 v[202:203], v253 offset:59840
    ds_read_b64_tr_b16 v[204:205], v253 offset:59360
    ds_read_b64_tr_b16 v[206:207], v253 offset:59872
    v_mbcnt_lo_u32_b32 v251, -1, 0
    v_mbcnt_hi_u32_b32 v251, -1, v251
    s_mul_i32 s31, s28, 6912
    s_add_u32 s31, s31, 136192
    s_movk_i32 s34, 272
    s_mul_i32 s35, s28, 12288
    v_and_b32_e32 v249, 15, v251
    v_lshrrev_b32_e64 v250, 4, v251
    v_mul_u32_u24_e64 v248, s34, v249
    v_lshl_add_u32 v248, v250, 3, v248
    v_add_u32_e64 v248, s31, v248
    v_mul_u32_u24_e64 v250, s34, v250
    v_lshl_add_u32 v249, v249, 4, v250
    v_add_u32_e64 v249, s31, v249
    v_lshlrev_b32_e64 v250, 4, v251
    v_add_u32_e64 v250, s35, v250
    v_rcp_f32_e64 v240, v224
    v_rcp_f32_e64 v242, v228
    v_rcp_f32_e32 v244, v232
    s_waitcnt lgkmcnt(12)
    v_mfma_f32_16x16x32_bf16 v[0:3], v[208:211], v[168:171], v[0:3]
    v_mfma_f32_16x16x32_bf16 v[4:7], v[212:215], v[168:171], v[4:7]
    s_waitcnt lgkmcnt(8)
    v_mfma_f32_16x16x32_bf16 v[8:11], v[216:219], v[168:171], v[8:11]
    v_mfma_f32_16x16x32_bf16 v[12:15], v[220:223], v[168:171], v[12:15]
    s_waitcnt lgkmcnt(4)
    v_mfma_f32_16x16x32_bf16 v[16:19], v[192:195], v[168:171], v[16:19]
    v_mfma_f32_16x16x32_bf16 v[20:23], v[196:199], v[168:171], v[20:23]
    s_waitcnt lgkmcnt(0)
    v_mfma_f32_16x16x32_bf16 v[24:27], v[200:203], v[168:171], v[24:27]
    v_mul_f32_e32 v0, v0, v240
    v_mul_f32_e64 v1, v1, v240
    v_mul_f32_e64 v2, v2, v240
    v_mul_f32_e64 v3, v3, v240
    v_mfma_f32_16x16x32_bf16 v[28:31], v[204:207], v[168:171], v[28:31]
    v_cvt_pk_bf16_f32 v0, v0, v1
    v_cvt_pk_bf16_f32 v1, v2, v3
    v_mul_f32_e64 v4, v4, v240
    v_mul_f32_e64 v5, v5, v240
    v_mfma_f32_16x16x32_bf16 v[32:35], v[208:211], v[176:179], v[32:35]
    v_mul_f32_e64 v6, v6, v240
    v_mul_f32_e64 v7, v7, v240
    v_cvt_pk_bf16_f32 v4, v4, v5
    v_cvt_pk_bf16_f32 v5, v6, v7
    v_mfma_f32_16x16x32_bf16 v[36:39], v[212:215], v[176:179], v[36:39]
    v_mul_f32_e64 v8, v8, v240
    v_mul_f32_e64 v9, v9, v240
    v_mul_f32_e64 v10, v10, v240
    v_mul_f32_e64 v11, v11, v240
    v_mfma_f32_16x16x32_bf16 v[40:43], v[216:219], v[176:179], v[40:43]
    v_cvt_pk_bf16_f32 v8, v8, v9
    v_cvt_pk_bf16_f32 v9, v10, v11
    v_mul_f32_e64 v12, v12, v240
    v_mul_f32_e64 v13, v13, v240
    v_mfma_f32_16x16x32_bf16 v[44:47], v[220:223], v[176:179], v[44:47]
    v_mul_f32_e64 v14, v14, v240
    v_mul_f32_e64 v15, v15, v240
    v_cvt_pk_bf16_f32 v12, v12, v13
    v_cvt_pk_bf16_f32 v13, v14, v15
    v_mfma_f32_16x16x32_bf16 v[48:51], v[192:195], v[176:179], v[48:51]
    v_mul_f32_e64 v16, v16, v240
    v_mul_f32_e64 v17, v17, v240
    v_mul_f32_e64 v18, v18, v240
    v_mul_f32_e64 v19, v19, v240
    v_mfma_f32_16x16x32_bf16 v[52:55], v[196:199], v[176:179], v[52:55]
    v_cvt_pk_bf16_f32 v16, v16, v17
    v_cvt_pk_bf16_f32 v17, v18, v19
    v_mul_f32_e64 v20, v20, v240
    v_mul_f32_e64 v21, v21, v240
    v_mfma_f32_16x16x32_bf16 v[56:59], v[200:203], v[176:179], v[56:59]
    v_mul_f32_e64 v22, v22, v240
    v_mul_f32_e64 v23, v23, v240
    v_cvt_pk_bf16_f32 v20, v20, v21
    v_cvt_pk_bf16_f32 v21, v22, v23
    v_mfma_f32_16x16x32_bf16 v[60:63], v[204:207], v[176:179], v[60:63]
    v_mul_f32_e64 v24, v24, v240
    v_mul_f32_e64 v25, v25, v240
    v_mul_f32_e64 v26, v26, v240
    v_mul_f32_e64 v27, v27, v240
    v_mfma_f32_16x16x32_bf16 v[64:67], v[208:211], v[184:187], v[64:67]
    v_cvt_pk_bf16_f32 v24, v24, v25
    v_cvt_pk_bf16_f32 v25, v26, v27
    v_mul_f32_e64 v28, v28, v240
    v_mul_f32_e64 v29, v29, v240
    v_mfma_f32_16x16x32_bf16 v[68:71], v[212:215], v[184:187], v[68:71]
    v_mul_f32_e64 v30, v30, v240
    v_mul_f32_e64 v31, v31, v240
    v_cvt_pk_bf16_f32 v28, v28, v29
    v_cvt_pk_bf16_f32 v29, v30, v31
    v_mfma_f32_16x16x32_bf16 v[72:75], v[216:219], v[184:187], v[72:75]
    ds_write_b64 v248, v[0:1] offset:0
    ds_write_b64 v248, v[4:5] offset:32
    ds_write_b64 v248, v[8:9] offset:64
    ds_write_b64 v248, v[12:13] offset:96
    v_mfma_f32_16x16x32_bf16 v[76:79], v[220:223], v[184:187], v[76:79]
    ds_write_b64 v248, v[16:17] offset:128
    ds_write_b64 v248, v[20:21] offset:160
    ds_write_b64 v248, v[24:25] offset:192
    ds_write_b64 v248, v[28:29] offset:224
    v_mfma_f32_16x16x32_bf16 v[80:83], v[192:195], v[184:187], v[80:83]
    ds_read_b128 v[96:99], v249 offset:0
    ds_read_b128 v[100:103], v249 offset:1088
    ds_read_b128 v[104:107], v249 offset:2176
    ds_read_b128 v[108:111], v249 offset:3264
    v_mfma_f32_16x16x32_bf16 v[84:87], v[196:199], v[184:187], v[84:87]
    s_waitcnt lgkmcnt(3)
    buffer_store_dwordx4 v[96:99], v250, s[24:27], 0 offen offset:0 nt
    s_waitcnt lgkmcnt(2)
    buffer_store_dwordx4 v[100:103], v250, s[24:27], 0 offen offset:1024 nt
    s_waitcnt lgkmcnt(1)
    buffer_store_dwordx4 v[104:107], v250, s[24:27], 0 offen offset:2048 nt
    s_waitcnt lgkmcnt(0)
    buffer_store_dwordx4 v[108:111], v250, s[24:27], 0 offen offset:3072 nt
    v_mfma_f32_16x16x32_bf16 v[88:91], v[200:203], v[184:187], v[88:91]
    v_mul_f32_e64 v32, v32, v242
    v_mul_f32_e64 v33, v33, v242
    v_mul_f32_e64 v34, v34, v242
    v_mul_f32_e64 v35, v35, v242
    v_mfma_f32_16x16x32_bf16 v[92:95], v[204:207], v[184:187], v[92:95]
    v_cvt_pk_bf16_f32 v32, v32, v33
    v_cvt_pk_bf16_f32 v33, v34, v35
    v_mul_f32_e64 v36, v36, v242
    v_mul_f32_e64 v37, v37, v242
    v_mul_f32_e64 v38, v38, v242
    v_mul_f32_e64 v39, v39, v242
    v_cvt_pk_bf16_f32 v36, v36, v37
    v_cvt_pk_bf16_f32 v37, v38, v39
    v_mul_f32_e64 v40, v40, v242
    v_mul_f32_e64 v41, v41, v242
    v_mul_f32_e64 v42, v42, v242
    v_mul_f32_e64 v43, v43, v242
    v_cvt_pk_bf16_f32 v40, v40, v41
    v_cvt_pk_bf16_f32 v41, v42, v43
    v_mul_f32_e64 v44, v44, v242
    v_mul_f32_e64 v45, v45, v242
    v_mul_f32_e64 v46, v46, v242
    v_mul_f32_e64 v47, v47, v242
    v_cvt_pk_bf16_f32 v44, v44, v45
    v_cvt_pk_bf16_f32 v45, v46, v47
    v_mul_f32_e64 v48, v48, v242
    v_mul_f32_e64 v49, v49, v242
    v_mul_f32_e64 v50, v50, v242
    v_mul_f32_e64 v51, v51, v242
    v_cvt_pk_bf16_f32 v48, v48, v49
    v_cvt_pk_bf16_f32 v49, v50, v51
    v_mul_f32_e64 v52, v52, v242
    v_mul_f32_e64 v53, v53, v242
    v_mul_f32_e64 v54, v54, v242
    v_mul_f32_e64 v55, v55, v242
    v_cvt_pk_bf16_f32 v52, v52, v53
    v_cvt_pk_bf16_f32 v53, v54, v55
    v_mul_f32_e64 v56, v56, v242
    v_mul_f32_e64 v57, v57, v242
    v_mul_f32_e64 v58, v58, v242
    v_mul_f32_e64 v59, v59, v242
    v_cvt_pk_bf16_f32 v56, v56, v57
    v_cvt_pk_bf16_f32 v57, v58, v59
    v_mul_f32_e64 v60, v60, v242
    v_mul_f32_e64 v61, v61, v242
    v_mul_f32_e64 v62, v62, v242
    v_mul_f32_e64 v63, v63, v242
    v_cvt_pk_bf16_f32 v60, v60, v61
    v_cvt_pk_bf16_f32 v61, v62, v63
    ds_write_b64 v248, v[32:33] offset:0
    ds_write_b64 v248, v[36:37] offset:32
    ds_write_b64 v248, v[40:41] offset:64
    ds_write_b64 v248, v[44:45] offset:96
    ds_write_b64 v248, v[48:49] offset:128
    ds_write_b64 v248, v[52:53] offset:160
    ds_write_b64 v248, v[56:57] offset:192
    ds_write_b64 v248, v[60:61] offset:224
    ds_read_b128 v[112:115], v249 offset:0
    ds_read_b128 v[116:119], v249 offset:1088
    ds_read_b128 v[120:123], v249 offset:2176
    ds_read_b128 v[124:127], v249 offset:3264
    v_pk_mul_f32 v[64:65], v[64:65], v[244:245] op_sel_hi:[1,0]
    v_pk_mul_f32 v[66:67], v[66:67], v[244:245] op_sel_hi:[1,0]
    v_cvt_pk_bf16_f32 v64, v64, v65
    v_cvt_pk_bf16_f32 v65, v66, v67
    v_pk_mul_f32 v[68:69], v[68:69], v[244:245] op_sel_hi:[1,0]
    v_pk_mul_f32 v[70:71], v[70:71], v[244:245] op_sel_hi:[1,0]
    v_cvt_pk_bf16_f32 v68, v68, v69
    v_cvt_pk_bf16_f32 v69, v70, v71
    v_pk_mul_f32 v[72:73], v[72:73], v[244:245] op_sel_hi:[1,0]
    v_pk_mul_f32 v[74:75], v[74:75], v[244:245] op_sel_hi:[1,0]
    v_cvt_pk_bf16_f32 v72, v72, v73
    v_cvt_pk_bf16_f32 v73, v74, v75
    v_pk_mul_f32 v[76:77], v[76:77], v[244:245] op_sel_hi:[1,0]
    v_pk_mul_f32 v[78:79], v[78:79], v[244:245] op_sel_hi:[1,0]
    v_cvt_pk_bf16_f32 v76, v76, v77
    v_cvt_pk_bf16_f32 v77, v78, v79
    s_waitcnt lgkmcnt(3)
    buffer_store_dwordx4 v[112:115], v250, s[24:27], s32 offen offset:0 nt
    s_waitcnt lgkmcnt(2)
    buffer_store_dwordx4 v[116:119], v250, s[24:27], s32 offen offset:1024 nt
    s_waitcnt lgkmcnt(1)
    buffer_store_dwordx4 v[120:123], v250, s[24:27], s32 offen offset:2048 nt
    s_waitcnt lgkmcnt(0)
    buffer_store_dwordx4 v[124:127], v250, s[24:27], s32 offen offset:3072 nt
    v_pk_mul_f32 v[80:81], v[80:81], v[244:245] op_sel_hi:[1,0]
    v_pk_mul_f32 v[82:83], v[82:83], v[244:245] op_sel_hi:[1,0]
    v_cvt_pk_bf16_f32 v80, v80, v81
    v_cvt_pk_bf16_f32 v81, v82, v83
    v_pk_mul_f32 v[84:85], v[84:85], v[244:245] op_sel_hi:[1,0]
    v_pk_mul_f32 v[86:87], v[86:87], v[244:245] op_sel_hi:[1,0]
    v_cvt_pk_bf16_f32 v84, v84, v85
    v_cvt_pk_bf16_f32 v85, v86, v87
    v_pk_mul_f32 v[88:89], v[88:89], v[244:245] op_sel_hi:[1,0]
    v_pk_mul_f32 v[90:91], v[90:91], v[244:245] op_sel_hi:[1,0]
    v_cvt_pk_bf16_f32 v88, v88, v89
    v_cvt_pk_bf16_f32 v89, v90, v91
    v_pk_mul_f32 v[92:93], v[92:93], v[244:245] op_sel_hi:[1,0]
    v_pk_mul_f32 v[94:95], v[94:95], v[244:245] op_sel_hi:[1,0]
    v_cvt_pk_bf16_f32 v92, v92, v93
    v_cvt_pk_bf16_f32 v93, v94, v95
    ds_write_b64 v248, v[64:65] offset:0
    ds_write_b64 v248, v[68:69] offset:32
    ds_write_b64 v248, v[72:73] offset:64
    ds_write_b64 v248, v[76:77] offset:96
    ds_write_b64 v248, v[80:81] offset:128
    ds_write_b64 v248, v[84:85] offset:160
    ds_write_b64 v248, v[88:89] offset:192
    ds_write_b64 v248, v[92:93] offset:224
    ds_read_b128 v[128:131], v249 offset:0
    ds_read_b128 v[132:135], v249 offset:1088
    ds_read_b128 v[136:139], v249 offset:2176
    ds_read_b128 v[140:143], v249 offset:3264
    s_waitcnt lgkmcnt(3)
    buffer_store_dwordx4 v[128:131], v250, s[24:27], s33 offen offset:0 nt
    s_waitcnt lgkmcnt(2)
    buffer_store_dwordx4 v[132:135], v250, s[24:27], s33 offen offset:1024 nt
    s_waitcnt lgkmcnt(1)
    buffer_store_dwordx4 v[136:139], v250, s[24:27], s33 offen offset:2048 nt
    s_waitcnt lgkmcnt(0)
    buffer_store_dwordx4 v[140:143], v250, s[24:27], s33 offen offset:3072 nt
    s_endpgm
L_w0:
    ds_read_b32 v194, v254 offset:2080
    s_waitcnt lgkmcnt(0)
    v_cmp_gt_u32 vcc, s47, v194
    s_cbranch_vccnz L_w0
    s_branch L_w0_ret
L_w1:
    ds_read_b32 v194, v254 offset:1024
    s_waitcnt lgkmcnt(0)
    v_cmp_gt_u32 vcc, s47, v194
    s_cbranch_vccnz L_w1
    s_branch L_w1_ret
L_m0_slow:
L_m0_slow_pl:
    ds_read_b32 v194, v254 offset:17920
    s_waitcnt lgkmcnt(0)
    v_cmp_gt_u32 vcc, s47, v194
    s_cbranch_vccnz L_m0_slow_pls
    v_cmp_lt_f32 vcc, s30, v192
    s_cbranch_vccz L_m0_slow_ret
    ds_read_b64_tr_b16 v[212:213], v253 offset:8608
    v_mfma_f32_16x16x32_bf16 v[8:11], v[216:219], v[144:147], v[8:11]
    ds_read_b64_tr_b16 v[214:215], v253 offset:9120
    v_mfma_f32_16x16x32_bf16 v[40:43], v[216:219], v[152:155], v[40:43]
    v_mfma_f32_16x16x32_bf16 v[72:75], v[216:219], v[160:163], v[72:75]
    ds_read_b64_tr_b16 v[216:217], v253 offset:8640
    v_mfma_f32_16x16x32_bf16 v[12:15], v[220:223], v[144:147], v[12:15]
    ds_read_b64_tr_b16 v[218:219], v253 offset:9152
    v_mfma_f32_16x16x32_bf16 v[44:47], v[220:223], v[152:155], v[44:47]
    v_mfma_f32_16x16x32_bf16 v[76:79], v[220:223], v[160:163], v[76:79]
    s_waitcnt lgkmcnt(2)
    ds_read_b64_tr_b16 v[220:221], v253 offset:8672
    v_mfma_f32_16x16x32_bf16 v[16:19], v[208:211], v[144:147], v[16:19]
    ds_read_b64_tr_b16 v[222:223], v253 offset:9184
    v_mfma_f32_16x16x32_bf16 v[48:51], v[208:211], v[152:155], v[48:51]
    v_mfma_f32_16x16x32_bf16 v[80:83], v[208:211], v[160:163], v[80:83]
    v_mfma_f32_16x16x32_bf16 v[20:23], v[212:215], v[144:147], v[20:23]
    v_mfma_f32_16x16x32_bf16 v[52:55], v[212:215], v[152:155], v[52:55]
    v_mfma_f32_16x16x32_bf16 v[84:87], v[212:215], v[160:163], v[84:87]
    s_waitcnt lgkmcnt(0)
    ds_inc_u32 v255, v236
    v_mfma_f32_16x16x32_bf16 v[24:27], v[216:219], v[144:147], v[24:27]
    v_mfma_f32_16x16x32_bf16 v[56:59], v[216:219], v[152:155], v[56:59]
    v_mfma_f32_16x16x32_bf16 v[88:91], v[216:219], v[160:163], v[88:91]
    v_mfma_f32_16x16x32_bf16 v[28:31], v[220:223], v[144:147], v[28:31]
    v_mfma_f32_16x16x32_bf16 v[60:63], v[220:223], v[152:155], v[60:63]
    v_mfma_f32_16x16x32_bf16 v[92:95], v[220:223], v[160:163], v[92:95]
    s_waitcnt lgkmcnt(0)
    s_nop 15
    v_max3_f32 v198, v168, v169, v170
    v_max3_f32 v198, v198, v171, v172
    v_max3_f32 v198, v198, v173, v174
    v_max3_f32 v198, v198, v175, 0
    v_mov_b32 v199, v198
    v_mov_b32 v200, v198
    s_nop 1
    v_permlane16_swap_b32 v199, v200
    s_nop 1
    v_max_f32 v198, v199, v200
    v_mov_b32 v199, v198
    v_mov_b32 v200, v198
    s_nop 1
    v_permlane32_swap_b32 v199, v200
    s_nop 1
    v_max_f32 v198, v199, v200
    v_sub_f32 v240, v240, v198
    v_sub_f32 v241, v241, v198
    v_sub_f32 v242, v242, v198
    v_sub_f32 v243, v243, v198
    v_sub_f32 v168, v168, v198
    v_sub_f32 v169, v169, v198
    v_sub_f32 v170, v170, v198
    v_sub_f32 v171, v171, v198
    v_sub_f32 v172, v172, v198
    v_sub_f32 v173, v173, v198
    v_sub_f32 v174, v174, v198
    v_sub_f32 v175, v175, v198
    v_exp_f32 v199, -v198
    s_nop 1
    v_mul_f32 v224, v224, v199
    v_mul_f32 v225, v225, v199
    v_mul_f32 v226, v226, v199
    v_mul_f32 v227, v227, v199
    v_mul_f32 v0, v0, v199
    v_mul_f32 v1, v1, v199
    v_mul_f32 v2, v2, v199
    v_mul_f32 v3, v3, v199
    v_mul_f32 v4, v4, v199
    v_mul_f32 v5, v5, v199
    v_mul_f32 v6, v6, v199
    v_mul_f32 v7, v7, v199
    v_mul_f32 v8, v8, v199
    v_mul_f32 v9, v9, v199
    v_mul_f32 v10, v10, v199
    v_mul_f32 v11, v11, v199
    v_mul_f32 v12, v12, v199
    v_mul_f32 v13, v13, v199
    v_mul_f32 v14, v14, v199
    v_mul_f32 v15, v15, v199
    v_mul_f32 v16, v16, v199
    v_mul_f32 v17, v17, v199
    v_mul_f32 v18, v18, v199
    v_mul_f32 v19, v19, v199
    v_mul_f32 v20, v20, v199
    v_mul_f32 v21, v21, v199
    v_mul_f32 v22, v22, v199
    v_mul_f32 v23, v23, v199
    v_mul_f32 v24, v24, v199
    v_mul_f32 v25, v25, v199
    v_mul_f32 v26, v26, v199
    v_mul_f32 v27, v27, v199
    v_mul_f32 v28, v28, v199
    v_mul_f32 v29, v29, v199
    v_mul_f32 v30, v30, v199
    v_mul_f32 v31, v31, v199
    v_max3_f32 v198, v176, v177, v178
    v_max3_f32 v198, v198, v179, v180
    v_max3_f32 v198, v198, v181, v182
    v_max3_f32 v198, v198, v183, 0
    v_mov_b32 v199, v198
    v_mov_b32 v200, v198
    s_nop 1
    v_permlane16_swap_b32 v199, v200
    s_nop 1
    v_max_f32 v198, v199, v200
    v_mov_b32 v199, v198
    v_mov_b32 v200, v198
    s_nop 1
    v_permlane32_swap_b32 v199, v200
    s_nop 1
    v_max_f32 v198, v199, v200
    v_sub_f32 v244, v244, v198
    v_sub_f32 v245, v245, v198
    v_sub_f32 v246, v246, v198
    v_sub_f32 v247, v247, v198
    v_sub_f32 v176, v176, v198
    v_sub_f32 v177, v177, v198
    v_sub_f32 v178, v178, v198
    v_sub_f32 v179, v179, v198
    v_sub_f32 v180, v180, v198
    v_sub_f32 v181, v181, v198
    v_sub_f32 v182, v182, v198
    v_sub_f32 v183, v183, v198
    v_exp_f32 v199, -v198
    s_nop 1
    v_mul_f32 v228, v228, v199
    v_mul_f32 v229, v229, v199
    v_mul_f32 v230, v230, v199
    v_mul_f32 v231, v231, v199
    v_mul_f32 v32, v32, v199
    v_mul_f32 v33, v33, v199
    v_mul_f32 v34, v34, v199
    v_mul_f32 v35, v35, v199
    v_mul_f32 v36, v36, v199
    v_mul_f32 v37, v37, v199
    v_mul_f32 v38, v38, v199
    v_mul_f32 v39, v39, v199
    v_mul_f32 v40, v40, v199
    v_mul_f32 v41, v41, v199
    v_mul_f32 v42, v42, v199
    v_mul_f32 v43, v43, v199
    v_mul_f32 v44, v44, v199
    v_mul_f32 v45, v45, v199
    v_mul_f32 v46, v46, v199
    v_mul_f32 v47, v47, v199
    v_mul_f32 v48, v48, v199
    v_mul_f32 v49, v49, v199
    v_mul_f32 v50, v50, v199
    v_mul_f32 v51, v51, v199
    v_mul_f32 v52, v52, v199
    v_mul_f32 v53, v53, v199
    v_mul_f32 v54, v54, v199
    v_mul_f32 v55, v55, v199
    v_mul_f32 v56, v56, v199
    v_mul_f32 v57, v57, v199
    v_mul_f32 v58, v58, v199
    v_mul_f32 v59, v59, v199
    v_mul_f32 v60, v60, v199
    v_mul_f32 v61, v61, v199
    v_mul_f32 v62, v62, v199
    v_mul_f32 v63, v63, v199
    v_max3_f32 v198, v184, v185, v186
    v_max3_f32 v198, v198, v187, v188
    v_max3_f32 v198, v198, v189, v190
    v_max3_f32 v198, v198, v191, 0
    v_mov_b32 v199, v198
    v_mov_b32 v200, v198
    s_nop 1
    v_permlane16_swap_b32 v199, v200
    s_nop 1
    v_max_f32 v198, v199, v200
    v_mov_b32 v199, v198
    v_mov_b32 v200, v198
    s_nop 1
    v_permlane32_swap_b32 v199, v200
    s_nop 1
    v_max_f32 v198, v199, v200
    v_sub_f32 v248, v248, v198
    v_sub_f32 v249, v249, v198
    v_sub_f32 v250, v250, v198
    v_sub_f32 v251, v251, v198
    v_sub_f32 v184, v184, v198
    v_sub_f32 v185, v185, v198
    v_sub_f32 v186, v186, v198
    v_sub_f32 v187, v187, v198
    v_sub_f32 v188, v188, v198
    v_sub_f32 v189, v189, v198
    v_sub_f32 v190, v190, v198
    v_sub_f32 v191, v191, v198
    v_exp_f32 v199, -v198
    s_nop 1
    v_mul_f32 v232, v232, v199
    v_mul_f32 v233, v233, v199
    v_mul_f32 v234, v234, v199
    v_mul_f32 v235, v235, v199
    v_mul_f32 v64, v64, v199
    v_mul_f32 v65, v65, v199
    v_mul_f32 v66, v66, v199
    v_mul_f32 v67, v67, v199
    v_mul_f32 v68, v68, v199
    v_mul_f32 v69, v69, v199
    v_mul_f32 v70, v70, v199
    v_mul_f32 v71, v71, v199
    v_mul_f32 v72, v72, v199
    v_mul_f32 v73, v73, v199
    v_mul_f32 v74, v74, v199
    v_mul_f32 v75, v75, v199
    v_mul_f32 v76, v76, v199
    v_mul_f32 v77, v77, v199
    v_mul_f32 v78, v78, v199
    v_mul_f32 v79, v79, v199
    v_mul_f32 v80, v80, v199
    v_mul_f32 v81, v81, v199
    v_mul_f32 v82, v82, v199
    v_mul_f32 v83, v83, v199
    v_mul_f32 v84, v84, v199
    v_mul_f32 v85, v85, v199
    v_mul_f32 v86, v86, v199
    v_mul_f32 v87, v87, v199
    v_mul_f32 v88, v88, v199
    v_mul_f32 v89, v89, v199
    v_mul_f32 v90, v90, v199
    v_mul_f32 v91, v91, v199
    v_mul_f32 v92, v92, v199
    v_mul_f32 v93, v93, v199
    v_mul_f32 v94, v94, v199
    v_mul_f32 v95, v95, v199
    v_exp_f32 v168, v168
    v_exp_f32 v169, v169
    v_exp_f32 v170, v170
    v_exp_f32 v171, v171
    v_exp_f32 v172, v172
    v_exp_f32 v173, v173
    v_exp_f32 v174, v174
    v_exp_f32 v175, v175
    v_exp_f32 v176, v176
    v_exp_f32 v177, v177
    v_exp_f32 v178, v178
    v_exp_f32 v179, v179
    s_nop 3
    ds_read_b128 v[192:195], v252 offset:16896
    ds_read_b128 v[196:199], v252 offset:16960
    ds_read_b128 v[200:203], v252 offset:17024
    ds_read_b128 v[204:207], v252 offset:17088
    s_branch L_m0_end
L_m0_slow_pls:
    s_branch L_m0_slow_pl
L_m1_slow:
L_m1_slow_pl:
    ds_read_b32 v194, v254 offset:34816
    s_waitcnt lgkmcnt(0)
    v_cmp_gt_u32 vcc, s47, v194
    s_cbranch_vccnz L_m1_slow_pls
    v_cmp_lt_f32 vcc, s30, v192
    s_cbranch_vccz L_m1_slow_ret
    ds_read_b64_tr_b16 v[212:213], v253 offset:25504
    v_mfma_f32_16x16x32_bf16 v[8:11], v[216:219], v[168:171], v[8:11]
    ds_read_b64_tr_b16 v[214:215], v253 offset:26016
    v_mfma_f32_16x16x32_bf16 v[40:43], v[216:219], v[176:179], v[40:43]
    v_mfma_f32_16x16x32_bf16 v[72:75], v[216:219], v[184:187], v[72:75]
    ds_read_b64_tr_b16 v[216:217], v253 offset:25536
    v_mfma_f32_16x16x32_bf16 v[12:15], v[220:223], v[168:171], v[12:15]
    ds_read_b64_tr_b16 v[218:219], v253 offset:26048
    v_mfma_f32_16x16x32_bf16 v[44:47], v[220:223], v[176:179], v[44:47]
    v_mfma_f32_16x16x32_bf16 v[76:79], v[220:223], v[184:187], v[76:79]
    s_waitcnt lgkmcnt(2)
    ds_read_b64_tr_b16 v[220:221], v253 offset:25568
    v_mfma_f32_16x16x32_bf16 v[16:19], v[208:211], v[168:171], v[16:19]
    ds_read_b64_tr_b16 v[222:223], v253 offset:26080
    v_mfma_f32_16x16x32_bf16 v[48:51], v[208:211], v[176:179], v[48:51]
    v_mfma_f32_16x16x32_bf16 v[80:83], v[208:211], v[184:187], v[80:83]
    v_mfma_f32_16x16x32_bf16 v[20:23], v[212:215], v[168:171], v[20:23]
    v_mfma_f32_16x16x32_bf16 v[52:55], v[212:215], v[176:179], v[52:55]
    v_mfma_f32_16x16x32_bf16 v[84:87], v[212:215], v[184:187], v[84:87]
    s_waitcnt lgkmcnt(0)
    ds_inc_u32 v255, v236
    v_mfma_f32_16x16x32_bf16 v[24:27], v[216:219], v[168:171], v[24:27]
    v_mfma_f32_16x16x32_bf16 v[56:59], v[216:219], v[176:179], v[56:59]
    v_mfma_f32_16x16x32_bf16 v[88:91], v[216:219], v[184:187], v[88:91]
    v_mfma_f32_16x16x32_bf16 v[28:31], v[220:223], v[168:171], v[28:31]
    v_mfma_f32_16x16x32_bf16 v[60:63], v[220:223], v[176:179], v[60:63]
    v_mfma_f32_16x16x32_bf16 v[92:95], v[220:223], v[184:187], v[92:95]
    s_waitcnt lgkmcnt(0)
    s_nop 15
    v_max3_f32 v198, v144, v145, v146
    v_max3_f32 v198, v198, v147, v148
    v_max3_f32 v198, v198, v149, v150
    v_max3_f32 v198, v198, v151, 0
    v_mov_b32 v199, v198
    v_mov_b32 v200, v198
    s_nop 1
    v_permlane16_swap_b32 v199, v200
    s_nop 1
    v_max_f32 v198, v199, v200
    v_mov_b32 v199, v198
    v_mov_b32 v200, v198
    s_nop 1
    v_permlane32_swap_b32 v199, v200
    s_nop 1
    v_max_f32 v198, v199, v200
    v_sub_f32 v240, v240, v198
    v_sub_f32 v241, v241, v198
    v_sub_f32 v242, v242, v198
    v_sub_f32 v243, v243, v198
    v_sub_f32 v144, v144, v198
    v_sub_f32 v145, v145, v198
    v_sub_f32 v146, v146, v198
    v_sub_f32 v147, v147, v198
    v_sub_f32 v148, v148, v198
    v_sub_f32 v149, v149, v198
    v_sub_f32 v150, v150, v198
    v_sub_f32 v151, v151, v198
    v_exp_f32 v199, -v198
    s_nop 1
    v_mul_f32 v224, v224, v199
    v_mul_f32 v225, v225, v199
    v_mul_f32 v226, v226, v199
    v_mul_f32 v227, v227, v199
    v_mul_f32 v0, v0, v199
    v_mul_f32 v1, v1, v199
    v_mul_f32 v2, v2, v199
    v_mul_f32 v3, v3, v199
    v_mul_f32 v4, v4, v199
    v_mul_f32 v5, v5, v199
    v_mul_f32 v6, v6, v199
    v_mul_f32 v7, v7, v199
    v_mul_f32 v8, v8, v199
    v_mul_f32 v9, v9, v199
    v_mul_f32 v10, v10, v199
    v_mul_f32 v11, v11, v199
    v_mul_f32 v12, v12, v199
    v_mul_f32 v13, v13, v199
    v_mul_f32 v14, v14, v199
    v_mul_f32 v15, v15, v199
    v_mul_f32 v16, v16, v199
    v_mul_f32 v17, v17, v199
    v_mul_f32 v18, v18, v199
    v_mul_f32 v19, v19, v199
    v_mul_f32 v20, v20, v199
    v_mul_f32 v21, v21, v199
    v_mul_f32 v22, v22, v199
    v_mul_f32 v23, v23, v199
    v_mul_f32 v24, v24, v199
    v_mul_f32 v25, v25, v199
    v_mul_f32 v26, v26, v199
    v_mul_f32 v27, v27, v199
    v_mul_f32 v28, v28, v199
    v_mul_f32 v29, v29, v199
    v_mul_f32 v30, v30, v199
    v_mul_f32 v31, v31, v199
    v_max3_f32 v198, v152, v153, v154
    v_max3_f32 v198, v198, v155, v156
    v_max3_f32 v198, v198, v157, v158
    v_max3_f32 v198, v198, v159, 0
    v_mov_b32 v199, v198
    v_mov_b32 v200, v198
    s_nop 1
    v_permlane16_swap_b32 v199, v200
    s_nop 1
    v_max_f32 v198, v199, v200
    v_mov_b32 v199, v198
    v_mov_b32 v200, v198
    s_nop 1
    v_permlane32_swap_b32 v199, v200
    s_nop 1
    v_max_f32 v198, v199, v200
    v_sub_f32 v244, v244, v198
    v_sub_f32 v245, v245, v198
    v_sub_f32 v246, v246, v198
    v_sub_f32 v247, v247, v198
    v_sub_f32 v152, v152, v198
    v_sub_f32 v153, v153, v198
    v_sub_f32 v154, v154, v198
    v_sub_f32 v155, v155, v198
    v_sub_f32 v156, v156, v198
    v_sub_f32 v157, v157, v198
    v_sub_f32 v158, v158, v198
    v_sub_f32 v159, v159, v198
    v_exp_f32 v199, -v198
    s_nop 1
    v_mul_f32 v228, v228, v199
    v_mul_f32 v229, v229, v199
    v_mul_f32 v230, v230, v199
    v_mul_f32 v231, v231, v199
    v_mul_f32 v32, v32, v199
    v_mul_f32 v33, v33, v199
    v_mul_f32 v34, v34, v199
    v_mul_f32 v35, v35, v199
    v_mul_f32 v36, v36, v199
    v_mul_f32 v37, v37, v199
    v_mul_f32 v38, v38, v199
    v_mul_f32 v39, v39, v199
    v_mul_f32 v40, v40, v199
    v_mul_f32 v41, v41, v199
    v_mul_f32 v42, v42, v199
    v_mul_f32 v43, v43, v199
    v_mul_f32 v44, v44, v199
    v_mul_f32 v45, v45, v199
    v_mul_f32 v46, v46, v199
    v_mul_f32 v47, v47, v199
    v_mul_f32 v48, v48, v199
    v_mul_f32 v49, v49, v199
    v_mul_f32 v50, v50, v199
    v_mul_f32 v51, v51, v199
    v_mul_f32 v52, v52, v199
    v_mul_f32 v53, v53, v199
    v_mul_f32 v54, v54, v199
    v_mul_f32 v55, v55, v199
    v_mul_f32 v56, v56, v199
    v_mul_f32 v57, v57, v199
    v_mul_f32 v58, v58, v199
    v_mul_f32 v59, v59, v199
    v_mul_f32 v60, v60, v199
    v_mul_f32 v61, v61, v199
    v_mul_f32 v62, v62, v199
    v_mul_f32 v63, v63, v199
    v_max3_f32 v198, v160, v161, v162
    v_max3_f32 v198, v198, v163, v164
    v_max3_f32 v198, v198, v165, v166
    v_max3_f32 v198, v198, v167, 0
    v_mov_b32 v199, v198
    v_mov_b32 v200, v198
    s_nop 1
    v_permlane16_swap_b32 v199, v200
    s_nop 1
    v_max_f32 v198, v199, v200
    v_mov_b32 v199, v198
    v_mov_b32 v200, v198
    s_nop 1
    v_permlane32_swap_b32 v199, v200
    s_nop 1
    v_max_f32 v198, v199, v200
    v_sub_f32 v248, v248, v198
    v_sub_f32 v249, v249, v198
    v_sub_f32 v250, v250, v198
    v_sub_f32 v251, v251, v198
    v_sub_f32 v160, v160, v198
    v_sub_f32 v161, v161, v198
    v_sub_f32 v162, v162, v198
    v_sub_f32 v163, v163, v198
    v_sub_f32 v164, v164, v198
    v_sub_f32 v165, v165, v198
    v_sub_f32 v166, v166, v198
    v_sub_f32 v167, v167, v198
    v_exp_f32 v199, -v198
    s_nop 1
    v_mul_f32 v232, v232, v199
    v_mul_f32 v233, v233, v199
    v_mul_f32 v234, v234, v199
    v_mul_f32 v235, v235, v199
    v_mul_f32 v64, v64, v199
    v_mul_f32 v65, v65, v199
    v_mul_f32 v66, v66, v199
    v_mul_f32 v67, v67, v199
    v_mul_f32 v68, v68, v199
    v_mul_f32 v69, v69, v199
    v_mul_f32 v70, v70, v199
    v_mul_f32 v71, v71, v199
    v_mul_f32 v72, v72, v199
    v_mul_f32 v73, v73, v199
    v_mul_f32 v74, v74, v199
    v_mul_f32 v75, v75, v199
    v_mul_f32 v76, v76, v199
    v_mul_f32 v77, v77, v199
    v_mul_f32 v78, v78, v199
    v_mul_f32 v79, v79, v199
    v_mul_f32 v80, v80, v199
    v_mul_f32 v81, v81, v199
    v_mul_f32 v82, v82, v199
    v_mul_f32 v83, v83, v199
    v_mul_f32 v84, v84, v199
    v_mul_f32 v85, v85, v199
    v_mul_f32 v86, v86, v199
    v_mul_f32 v87, v87, v199
    v_mul_f32 v88, v88, v199
    v_mul_f32 v89, v89, v199
    v_mul_f32 v90, v90, v199
    v_mul_f32 v91, v91, v199
    v_mul_f32 v92, v92, v199
    v_mul_f32 v93, v93, v199
    v_mul_f32 v94, v94, v199
    v_mul_f32 v95, v95, v199
    v_exp_f32 v144, v144
    v_exp_f32 v145, v145
    v_exp_f32 v146, v146
    v_exp_f32 v147, v147
    v_exp_f32 v148, v148
    v_exp_f32 v149, v149
    v_exp_f32 v150, v150
    v_exp_f32 v151, v151
    v_exp_f32 v152, v152
    v_exp_f32 v153, v153
    v_exp_f32 v154, v154
    v_exp_f32 v155, v155
    s_nop 3
    ds_read_b128 v[192:195], v252 offset:33792
    ds_read_b128 v[196:199], v252 offset:33856
    ds_read_b128 v[200:203], v252 offset:33920
    ds_read_b128 v[204:207], v252 offset:33984
    s_branch L_m1_end
L_m1_slow_pls:
    s_branch L_m1_slow_pl
L_m2_slow:
L_m2_slow_pl:
    ds_read_b32 v194, v254 offset:51712
    s_waitcnt lgkmcnt(0)
    v_cmp_gt_u32 vcc, s47, v194
    s_cbranch_vccnz L_m2_slow_pls
    v_cmp_lt_f32 vcc, s30, v192
    s_cbranch_vccz L_m2_slow_ret
    ds_read_b64_tr_b16 v[212:213], v253 offset:42400
    v_mfma_f32_16x16x32_bf16 v[8:11], v[216:219], v[144:147], v[8:11]
    ds_read_b64_tr_b16 v[214:215], v253 offset:42912
    v_mfma_f32_16x16x32_bf16 v[40:43], v[216:219], v[152:155], v[40:43]
    v_mfma_f32_16x16x32_bf16 v[72:75], v[216:219], v[160:163], v[72:75]
    ds_read_b64_tr_b16 v[216:217], v253 offset:42432
    v_mfma_f32_16x16x32_bf16 v[12:15], v[220:223], v[144:147], v[12:15]
    ds_read_b64_tr_b16 v[218:219], v253 offset:42944
    v_mfma_f32_16x16x32_bf16 v[44:47], v[220:223], v[152:155], v[44:47]
    v_mfma_f32_16x16x32_bf16 v[76:79], v[220:223], v[160:163], v[76:79]
    s_waitcnt lgkmcnt(2)
    ds_read_b64_tr_b16 v[220:221], v253 offset:42464
    v_mfma_f32_16x16x32_bf16 v[16:19], v[208:211], v[144:147], v[16:19]
    ds_read_b64_tr_b16 v[222:223], v253 offset:42976
    v_mfma_f32_16x16x32_bf16 v[48:51], v[208:211], v[152:155], v[48:51]
    v_mfma_f32_16x16x32_bf16 v[80:83], v[208:211], v[160:163], v[80:83]
    v_mfma_f32_16x16x32_bf16 v[20:23], v[212:215], v[144:147], v[20:23]
    v_mfma_f32_16x16x32_bf16 v[52:55], v[212:215], v[152:155], v[52:55]
    v_mfma_f32_16x16x32_bf16 v[84:87], v[212:215], v[160:163], v[84:87]
    s_waitcnt lgkmcnt(0)
    ds_inc_u32 v255, v236
    v_mfma_f32_16x16x32_bf16 v[24:27], v[216:219], v[144:147], v[24:27]
    v_mfma_f32_16x16x32_bf16 v[56:59], v[216:219], v[152:155], v[56:59]
    v_mfma_f32_16x16x32_bf16 v[88:91], v[216:219], v[160:163], v[88:91]
    v_mfma_f32_16x16x32_bf16 v[28:31], v[220:223], v[144:147], v[28:31]
    v_mfma_f32_16x16x32_bf16 v[60:63], v[220:223], v[152:155], v[60:63]
    v_mfma_f32_16x16x32_bf16 v[92:95], v[220:223], v[160:163], v[92:95]
    s_waitcnt lgkmcnt(0)
    s_nop 15
    v_max3_f32 v198, v168, v169, v170
    v_max3_f32 v198, v198, v171, v172
    v_max3_f32 v198, v198, v173, v174
    v_max3_f32 v198, v198, v175, 0
    v_mov_b32 v199, v198
    v_mov_b32 v200, v198
    s_nop 1
    v_permlane16_swap_b32 v199, v200
    s_nop 1
    v_max_f32 v198, v199, v200
    v_mov_b32 v199, v198
    v_mov_b32 v200, v198
    s_nop 1
    v_permlane32_swap_b32 v199, v200
    s_nop 1
    v_max_f32 v198, v199, v200
    v_sub_f32 v240, v240, v198
    v_sub_f32 v241, v241, v198
    v_sub_f32 v242, v242, v198
    v_sub_f32 v243, v243, v198
    v_sub_f32 v168, v168, v198
    v_sub_f32 v169, v169, v198
    v_sub_f32 v170, v170, v198
    v_sub_f32 v171, v171, v198
    v_sub_f32 v172, v172, v198
    v_sub_f32 v173, v173, v198
    v_sub_f32 v174, v174, v198
    v_sub_f32 v175, v175, v198
    v_exp_f32 v199, -v198
    s_nop 1
    v_mul_f32 v224, v224, v199
    v_mul_f32 v225, v225, v199
    v_mul_f32 v226, v226, v199
    v_mul_f32 v227, v227, v199
    v_mul_f32 v0, v0, v199
    v_mul_f32 v1, v1, v199
    v_mul_f32 v2, v2, v199
    v_mul_f32 v3, v3, v199
    v_mul_f32 v4, v4, v199
    v_mul_f32 v5, v5, v199
    v_mul_f32 v6, v6, v199
    v_mul_f32 v7, v7, v199
    v_mul_f32 v8, v8, v199
    v_mul_f32 v9, v9, v199
    v_mul_f32 v10, v10, v199
    v_mul_f32 v11, v11, v199
    v_mul_f32 v12, v12, v199
    v_mul_f32 v13, v13, v199
    v_mul_f32 v14, v14, v199
    v_mul_f32 v15, v15, v199
    v_mul_f32 v16, v16, v199
    v_mul_f32 v17, v17, v199
    v_mul_f32 v18, v18, v199
    v_mul_f32 v19, v19, v199
    v_mul_f32 v20, v20, v199
    v_mul_f32 v21, v21, v199
    v_mul_f32 v22, v22, v199
    v_mul_f32 v23, v23, v199
    v_mul_f32 v24, v24, v199
    v_mul_f32 v25, v25, v199
    v_mul_f32 v26, v26, v199
    v_mul_f32 v27, v27, v199
    v_mul_f32 v28, v28, v199
    v_mul_f32 v29, v29, v199
    v_mul_f32 v30, v30, v199
    v_mul_f32 v31, v31, v199
    v_max3_f32 v198, v176, v177, v178
    v_max3_f32 v198, v198, v179, v180
    v_max3_f32 v198, v198, v181, v182
    v_max3_f32 v198, v198, v183, 0
    v_mov_b32 v199, v198
    v_mov_b32 v200, v198
    s_nop 1
    v_permlane16_swap_b32 v199, v200
    s_nop 1
    v_max_f32 v198, v199, v200
    v_mov_b32 v199, v198
    v_mov_b32 v200, v198
    s_nop 1
    v_permlane32_swap_b32 v199, v200
    s_nop 1
    v_max_f32 v198, v199, v200
    v_sub_f32 v244, v244, v198
    v_sub_f32 v245, v245, v198
    v_sub_f32 v246, v246, v198
    v_sub_f32 v247, v247, v198
    v_sub_f32 v176, v176, v198
    v_sub_f32 v177, v177, v198
    v_sub_f32 v178, v178, v198
    v_sub_f32 v179, v179, v198
    v_sub_f32 v180, v180, v198
    v_sub_f32 v181, v181, v198
    v_sub_f32 v182, v182, v198
    v_sub_f32 v183, v183, v198
    v_exp_f32 v199, -v198
    s_nop 1
    v_mul_f32 v228, v228, v199
    v_mul_f32 v229, v229, v199
    v_mul_f32 v230, v230, v199
    v_mul_f32 v231, v231, v199
    v_mul_f32 v32, v32, v199
    v_mul_f32 v33, v33, v199
    v_mul_f32 v34, v34, v199
    v_mul_f32 v35, v35, v199
    v_mul_f32 v36, v36, v199
    v_mul_f32 v37, v37, v199
    v_mul_f32 v38, v38, v199
    v_mul_f32 v39, v39, v199
    v_mul_f32 v40, v40, v199
    v_mul_f32 v41, v41, v199
    v_mul_f32 v42, v42, v199
    v_mul_f32 v43, v43, v199
    v_mul_f32 v44, v44, v199
    v_mul_f32 v45, v45, v199
    v_mul_f32 v46, v46, v199
    v_mul_f32 v47, v47, v199
    v_mul_f32 v48, v48, v199
    v_mul_f32 v49, v49, v199
    v_mul_f32 v50, v50, v199
    v_mul_f32 v51, v51, v199
    v_mul_f32 v52, v52, v199
    v_mul_f32 v53, v53, v199
    v_mul_f32 v54, v54, v199
    v_mul_f32 v55, v55, v199
    v_mul_f32 v56, v56, v199
    v_mul_f32 v57, v57, v199
    v_mul_f32 v58, v58, v199
    v_mul_f32 v59, v59, v199
    v_mul_f32 v60, v60, v199
    v_mul_f32 v61, v61, v199
    v_mul_f32 v62, v62, v199
    v_mul_f32 v63, v63, v199
    v_max3_f32 v198, v184, v185, v186
    v_max3_f32 v198, v198, v187, v188
    v_max3_f32 v198, v198, v189, v190
    v_max3_f32 v198, v198, v191, 0
    v_mov_b32 v199, v198
    v_mov_b32 v200, v198
    s_nop 1
    v_permlane16_swap_b32 v199, v200
    s_nop 1
    v_max_f32 v198, v199, v200
    v_mov_b32 v199, v198
    v_mov_b32 v200, v198
    s_nop 1
    v_permlane32_swap_b32 v199, v200
    s_nop 1
    v_max_f32 v198, v199, v200
    v_sub_f32 v248, v248, v198
    v_sub_f32 v249, v249, v198
    v_sub_f32 v250, v250, v198
    v_sub_f32 v251, v251, v198
    v_sub_f32 v184, v184, v198
    v_sub_f32 v185, v185, v198
    v_sub_f32 v186, v186, v198
    v_sub_f32 v187, v187, v198
    v_sub_f32 v188, v188, v198
    v_sub_f32 v189, v189, v198
    v_sub_f32 v190, v190, v198
    v_sub_f32 v191, v191, v198
    v_exp_f32 v199, -v198
    s_nop 1
    v_mul_f32 v232, v232, v199
    v_mul_f32 v233, v233, v199
    v_mul_f32 v234, v234, v199
    v_mul_f32 v235, v235, v199
    v_mul_f32 v64, v64, v199
    v_mul_f32 v65, v65, v199
    v_mul_f32 v66, v66, v199
    v_mul_f32 v67, v67, v199
    v_mul_f32 v68, v68, v199
    v_mul_f32 v69, v69, v199
    v_mul_f32 v70, v70, v199
    v_mul_f32 v71, v71, v199
    v_mul_f32 v72, v72, v199
    v_mul_f32 v73, v73, v199
    v_mul_f32 v74, v74, v199
    v_mul_f32 v75, v75, v199
    v_mul_f32 v76, v76, v199
    v_mul_f32 v77, v77, v199
    v_mul_f32 v78, v78, v199
    v_mul_f32 v79, v79, v199
    v_mul_f32 v80, v80, v199
    v_mul_f32 v81, v81, v199
    v_mul_f32 v82, v82, v199
    v_mul_f32 v83, v83, v199
    v_mul_f32 v84, v84, v199
    v_mul_f32 v85, v85, v199
    v_mul_f32 v86, v86, v199
    v_mul_f32 v87, v87, v199
    v_mul_f32 v88, v88, v199
    v_mul_f32 v89, v89, v199
    v_mul_f32 v90, v90, v199
    v_mul_f32 v91, v91, v199
    v_mul_f32 v92, v92, v199
    v_mul_f32 v93, v93, v199
    v_mul_f32 v94, v94, v199
    v_mul_f32 v95, v95, v199
    v_exp_f32 v168, v168
    v_exp_f32 v169, v169
    v_exp_f32 v170, v170
    v_exp_f32 v171, v171
    v_exp_f32 v172, v172
    v_exp_f32 v173, v173
    v_exp_f32 v174, v174
    v_exp_f32 v175, v175
    v_exp_f32 v176, v176
    v_exp_f32 v177, v177
    v_exp_f32 v178, v178
    v_exp_f32 v179, v179
    s_nop 3
    ds_read_b128 v[192:195], v252 offset:50688
    ds_read_b128 v[196:199], v252 offset:50752
    ds_read_b128 v[200:203], v252 offset:50816
    ds_read_b128 v[204:207], v252 offset:50880
    s_branch L_m2_end
L_m2_slow_pls:
    s_branch L_m2_slow_pl
L_m3_slow:
L_m3_slow_pl:
    ds_read_b32 v194, v254 offset:1024
    s_waitcnt lgkmcnt(0)
    v_cmp_gt_u32 vcc, s47, v194
    s_cbranch_vccnz L_m3_slow_pls
    v_cmp_lt_f32 vcc, s30, v192
    s_cbranch_vccz L_m3_slow_ret
    ds_read_b64_tr_b16 v[212:213], v253 offset:59296
    v_mfma_f32_16x16x32_bf16 v[8:11], v[216:219], v[168:171], v[8:11]
    ds_read_b64_tr_b16 v[214:215], v253 offset:59808
    v_mfma_f32_16x16x32_bf16 v[40:43], v[216:219], v[176:179], v[40:43]
    v_mfma_f32_16x16x32_bf16 v[72:75], v[216:219], v[184:187], v[72:75]
    ds_read_b64_tr_b16 v[216:217], v253 offset:59328
    v_mfma_f32_16x16x32_bf16 v[12:15], v[220:223], v[168:171], v[12:15]
    ds_read_b64_tr_b16 v[218:219], v253 offset:59840
    v_mfma_f32_16x16x32_bf16 v[44:47], v[220:223], v[176:179], v[44:47]
    v_mfma_f32_16x16x32_bf16 v[76:79], v[220:223], v[184:187], v[76:79]
    s_waitcnt lgkmcnt(2)
    ds_read_b64_tr_b16 v[220:221], v253 offset:59360
    v_mfma_f32_16x16x32_bf16 v[16:19], v[208:211], v[168:171], v[16:19]
    ds_read_b64_tr_b16 v[222:223], v253 offset:59872
    v_mfma_f32_16x16x32_bf16 v[48:51], v[208:211], v[176:179], v[48:51]
    v_add_u32 v252, s39, v252
    v_mfma_f32_16x16x32_bf16 v[80:83], v[208:211], v[184:187], v[80:83]
    v_add_u32 v253, s39, v253
    v_mfma_f32_16x16x32_bf16 v[20:23], v[212:215], v[168:171], v[20:23]
    v_mfma_f32_16x16x32_bf16 v[52:55], v[212:215], v[176:179], v[52:55]
    v_mfma_f32_16x16x32_bf16 v[84:87], v[212:215], v[184:187], v[84:87]
    s_waitcnt lgkmcnt(0)
    ds_inc_u32 v255, v236
    v_mfma_f32_16x16x32_bf16 v[24:27], v[216:219], v[168:171], v[24:27]
    v_mfma_f32_16x16x32_bf16 v[56:59], v[216:219], v[176:179], v[56:59]
    v_mfma_f32_16x16x32_bf16 v[88:91], v[216:219], v[184:187], v[88:91]
    v_mfma_f32_16x16x32_bf16 v[28:31], v[220:223], v[168:171], v[28:31]
    v_mfma_f32_16x16x32_bf16 v[60:63], v[220:223], v[176:179], v[60:63]
    s_sub_u32 s39, 0, s39
    v_mfma_f32_16x16x32_bf16 v[92:95], v[220:223], v[184:187], v[92:95]
    s_waitcnt lgkmcnt(0)
    s_nop 15
    v_max3_f32 v198, v144, v145, v146
    v_max3_f32 v198, v198, v147, v148
    v_max3_f32 v198, v198, v149, v150
    v_max3_f32 v198, v198, v151, 0
    v_mov_b32 v199, v198
    v_mov_b32 v200, v198
    s_nop 1
    v_permlane16_swap_b32 v199, v200
    s_nop 1
    v_max_f32 v198, v199, v200
    v_mov_b32 v199, v198
    v_mov_b32 v200, v198
    s_nop 1
    v_permlane32_swap_b32 v199, v200
    s_nop 1
    v_max_f32 v198, v199, v200
    v_sub_f32 v240, v240, v198
    v_sub_f32 v241, v241, v198
    v_sub_f32 v242, v242, v198
    v_sub_f32 v243, v243, v198
    v_sub_f32 v144, v144, v198
    v_sub_f32 v145, v145, v198
    v_sub_f32 v146, v146, v198
    v_sub_f32 v147, v147, v198
    v_sub_f32 v148, v148, v198
    v_sub_f32 v149, v149, v198
    v_sub_f32 v150, v150, v198
    v_sub_f32 v151, v151, v198
    v_exp_f32 v199, -v198
    s_nop 1
    v_mul_f32 v224, v224, v199
    v_mul_f32 v225, v225, v199
    v_mul_f32 v226, v226, v199
    v_mul_f32 v227, v227, v199
    v_mul_f32 v0, v0, v199
    v_mul_f32 v1, v1, v199
    v_mul_f32 v2, v2, v199
    v_mul_f32 v3, v3, v199
    v_mul_f32 v4, v4, v199
    v_mul_f32 v5, v5, v199
    v_mul_f32 v6, v6, v199
    v_mul_f32 v7, v7, v199
    v_mul_f32 v8, v8, v199
    v_mul_f32 v9, v9, v199
    v_mul_f32 v10, v10, v199
    v_mul_f32 v11, v11, v199
    v_mul_f32 v12, v12, v199
    v_mul_f32 v13, v13, v199
    v_mul_f32 v14, v14, v199
    v_mul_f32 v15, v15, v199
    v_mul_f32 v16, v16, v199
    v_mul_f32 v17, v17, v199
    v_mul_f32 v18, v18, v199
    v_mul_f32 v19, v19, v199
    v_mul_f32 v20, v20, v199
    v_mul_f32 v21, v21, v199
    v_mul_f32 v22, v22, v199
    v_mul_f32 v23, v23, v199
    v_mul_f32 v24, v24, v199
    v_mul_f32 v25, v25, v199
    v_mul_f32 v26, v26, v199
    v_mul_f32 v27, v27, v199
    v_mul_f32 v28, v28, v199
    v_mul_f32 v29, v29, v199
    v_mul_f32 v30, v30, v199
    v_mul_f32 v31, v31, v199
    v_max3_f32 v198, v152, v153, v154
    v_max3_f32 v198, v198, v155, v156
    v_max3_f32 v198, v198, v157, v158
    v_max3_f32 v198, v198, v159, 0
    v_mov_b32 v199, v198
    v_mov_b32 v200, v198
    s_nop 1
    v_permlane16_swap_b32 v199, v200
    s_nop 1
    v_max_f32 v198, v199, v200
    v_mov_b32 v199, v198
    v_mov_b32 v200, v198
    s_nop 1
    v_permlane32_swap_b32 v199, v200
    s_nop 1
    v_max_f32 v198, v199, v200
    v_sub_f32 v244, v244, v198
    v_sub_f32 v245, v245, v198
    v_sub_f32 v246, v246, v198
    v_sub_f32 v247, v247, v198
    v_sub_f32 v152, v152, v198
    v_sub_f32 v153, v153, v198
    v_sub_f32 v154, v154, v198
    v_sub_f32 v155, v155, v198
    v_sub_f32 v156, v156, v198
    v_sub_f32 v157, v157, v198
    v_sub_f32 v158, v158, v198
    v_sub_f32 v159, v159, v198
    v_exp_f32 v199, -v198
    s_nop 1
    v_mul_f32 v228, v228, v199
    v_mul_f32 v229, v229, v199
    v_mul_f32 v230, v230, v199
    v_mul_f32 v231, v231, v199
    v_mul_f32 v32, v32, v199
    v_mul_f32 v33, v33, v199
    v_mul_f32 v34, v34, v199
    v_mul_f32 v35, v35, v199
    v_mul_f32 v36, v36, v199
    v_mul_f32 v37, v37, v199
    v_mul_f32 v38, v38, v199
    v_mul_f32 v39, v39, v199
    v_mul_f32 v40, v40, v199
    v_mul_f32 v41, v41, v199
    v_mul_f32 v42, v42, v199
    v_mul_f32 v43, v43, v199
    v_mul_f32 v44, v44, v199
    v_mul_f32 v45, v45, v199
    v_mul_f32 v46, v46, v199
    v_mul_f32 v47, v47, v199
    v_mul_f32 v48, v48, v199
    v_mul_f32 v49, v49, v199
    v_mul_f32 v50, v50, v199
    v_mul_f32 v51, v51, v199
    v_mul_f32 v52, v52, v199
    v_mul_f32 v53, v53, v199
    v_mul_f32 v54, v54, v199
    v_mul_f32 v55, v55, v199
    v_mul_f32 v56, v56, v199
    v_mul_f32 v57, v57, v199
    v_mul_f32 v58, v58, v199
    v_mul_f32 v59, v59, v199
    v_mul_f32 v60, v60, v199
    v_mul_f32 v61, v61, v199
    v_mul_f32 v62, v62, v199
    v_mul_f32 v63, v63, v199
    v_max3_f32 v198, v160, v161, v162
    v_max3_f32 v198, v198, v163, v164
    v_max3_f32 v198, v198, v165, v166
    v_max3_f32 v198, v198, v167, 0
    v_mov_b32 v199, v198
    v_mov_b32 v200, v198
    s_nop 1
    v_permlane16_swap_b32 v199, v200
    s_nop 1
    v_max_f32 v198, v199, v200
    v_mov_b32 v199, v198
    v_mov_b32 v200, v198
    s_nop 1
    v_permlane32_swap_b32 v199, v200
    s_nop 1
    v_max_f32 v198, v199, v200
    v_sub_f32 v248, v248, v198
    v_sub_f32 v249, v249, v198
    v_sub_f32 v250, v250, v198
    v_sub_f32 v251, v251, v198
    v_sub_f32 v160, v160, v198
    v_sub_f32 v161, v161, v198
    v_sub_f32 v162, v162, v198
    v_sub_f32 v163, v163, v198
    v_sub_f32 v164, v164, v198
    v_sub_f32 v165, v165, v198
    v_sub_f32 v166, v166, v198
    v_sub_f32 v167, v167, v198
    v_exp_f32 v199, -v198
    s_nop 1
    v_mul_f32 v232, v232, v199
    v_mul_f32 v233, v233, v199
    v_mul_f32 v234, v234, v199
    v_mul_f32 v235, v235, v199
    v_mul_f32 v64, v64, v199
    v_mul_f32 v65, v65, v199
    v_mul_f32 v66, v66, v199
    v_mul_f32 v67, v67, v199
    v_mul_f32 v68, v68, v199
    v_mul_f32 v69, v69, v199
    v_mul_f32 v70, v70, v199
    v_mul_f32 v71, v71, v199
    v_mul_f32 v72, v72, v199
    v_mul_f32 v73, v73, v199
    v_mul_f32 v74, v74, v199
    v_mul_f32 v75, v75, v199
    v_mul_f32 v76, v76, v199
    v_mul_f32 v77, v77, v199
    v_mul_f32 v78, v78, v199
    v_mul_f32 v79, v79, v199
    v_mul_f32 v80, v80, v199
    v_mul_f32 v81, v81, v199
    v_mul_f32 v82, v82, v199
    v_mul_f32 v83, v83, v199
    v_mul_f32 v84, v84, v199
    v_mul_f32 v85, v85, v199
    v_mul_f32 v86, v86, v199
    v_mul_f32 v87, v87, v199
    v_mul_f32 v88, v88, v199
    v_mul_f32 v89, v89, v199
    v_mul_f32 v90, v90, v199
    v_mul_f32 v91, v91, v199
    v_mul_f32 v92, v92, v199
    v_mul_f32 v93, v93, v199
    v_mul_f32 v94, v94, v199
    v_mul_f32 v95, v95, v199
    v_exp_f32 v144, v144
    v_exp_f32 v145, v145
    v_exp_f32 v146, v146
    v_exp_f32 v147, v147
    v_exp_f32 v148, v148
    v_exp_f32 v149, v149
    v_exp_f32 v150, v150
    v_exp_f32 v151, v151
    v_exp_f32 v152, v152
    v_exp_f32 v153, v153
    v_exp_f32 v154, v154
    v_exp_f32 v155, v155
    s_nop 3
    ds_read_b128 v[192:195], v252 offset:0
    ds_read_b128 v[196:199], v252 offset:64
    ds_read_b128 v[200:203], v252 offset:128
    ds_read_b128 v[204:207], v252 offset:192
    s_branch L_m3_end
L_m3_slow_pls:
    s_branch L_m3_slow_pl
.section .rodata,"a"
.p2align 6
.amdhsa_kernel standalone__gqa_softmax__near_ridge_kernel
  .amdhsa_next_free_vgpr 256
  .amdhsa_next_free_sgpr 56
  .amdhsa_accum_offset 256
  .amdhsa_group_segment_fixed_size 0
  .amdhsa_kernarg_size 48
  .amdhsa_user_sgpr_count 2
  .amdhsa_user_sgpr_kernarg_segment_ptr 1
  .amdhsa_system_sgpr_workgroup_id_x 1
.end_amdhsa_kernel
```
